```python
import torch

def _softmax(x, axis=-1):
    return torch.softmax(x, dim=axis)
def _gelu(x):
    return torch.nn.functional.gelu(x, approximate="tanh")
def _silu(x):
    return torch.nn.functional.silu(x)
def _sigmoid(x):
    return torch.sigmoid(x)
def _layernorm(x, axis=-1, eps=1e-5):
    m = x.mean(dim=axis, keepdim=True)
    v = x.var(dim=axis, keepdim=True, unbiased=False)
    return (x - m) / torch.sqrt(v + eps)
def _scatter_add(tgt, idx, src, axis=0):
    return tgt.clone().index_add_(axis, idx, src)
def _segment_sum(src, seg, n):
    out = torch.zeros((n,) + src.shape[1:], dtype=src.dtype)
    return out.index_add_(0, seg, src)
def _pad(x, pw):
    flat = tuple(v for pair in reversed(pw) for v in pair)
    return torch.nn.functional.pad(x, flat)

kernel_name = 'interleave_layers__mha_block__glu_gated_bilinear__prompt'

def setup_inputs():

    _w = (lambda a: (lambda t: t.to(torch.bfloat16) if t.is_floating_point() else t)(torch.as_tensor(a)))
    def _A_setup():
        B, S, D, H = 1, 2048, 512, 32
        return {
            "x": _w((lambda *s: torch.randn(*s, dtype=torch.bfloat16) * 0.05)(B, S, D)),
            "wqkv": _w((lambda *s: torch.randn(*s, dtype=torch.bfloat16) * 0.05)(D, 3 * D)),
            "wo": _w((lambda *s: torch.randn(*s, dtype=torch.bfloat16) * 0.05)(D, D)),
        }
    _A_in = _A_setup()

    def _B_setup():
        B, S, D, F = 1, 2048, 512, 1376
        return {
            "x": _w((lambda *s: torch.randn(*s, dtype=torch.bfloat16) * 0.05)(B, S, D)),
            "w_gate": _w((lambda *s: torch.randn(*s, dtype=torch.bfloat16) * 0.4)(D, F) * (D ** -0.5)),
            "w_up": _w((lambda *s: torch.randn(*s, dtype=torch.bfloat16) * 0.4)(D, F) * (D ** -0.5)),
            "w_down": _w((lambda *s: torch.randn(*s, dtype=torch.bfloat16) * 0.4)(F, D) * (F ** -0.5)),
        }
    _B_in = _B_setup()

    return {
        "A_x": _A_in["x"],
        "A_wqkv": _A_in["wqkv"],
        "A_wo": _A_in["wo"],
        "B_x": _B_in["x"],
        "B_w_gate": _B_in["w_gate"],
        "B_w_up": _B_in["w_up"],
        "B_w_down": _B_in["w_down"],
    }

def reference(A_x, A_wqkv, A_wo, B_x, B_w_gate, B_w_up, B_w_down):
    def _A_ref(x, wqkv, wo):
        B, S, D = x.shape
        H = 32
        Dh = D // H
        qkv = (lambda x, *d: x.permute(*d))((x @ wqkv).reshape(B, S, 3, H, Dh), 2, 0, 3, 1, 4)
        q, k, v = qkv[0], qkv[1], qkv[2]
        scores = torch.einsum("bhqd,bhkd->bhqk", q, k) * (Dh ** -0.5)
        p = _softmax(scores, axis=-1)
        o = torch.einsum("bhqk,bhkd->bhqd", p, v)
        return (lambda x, *d: x.permute(*d))(o, 0, 2, 1, 3).reshape(B, S, D) @ wo

    def _B_ref(x, w_gate, w_up, w_down):
        g = torch.einsum("bsd,df->bsf", x, w_gate)
        u = torch.einsum("bsd,df->bsf", x, w_up)
        h = g * u
        return torch.einsum("bsf,fd->bsd", h, w_down)

    x = A_x
    x = x + _A_ref(_layernorm(x, axis=-1), A_wqkv, A_wo)
    x = x + _B_ref(_layernorm(x, axis=-1), B_w_gate, B_w_up, B_w_down)
    x = x + _A_ref(_layernorm(x, axis=-1), A_wqkv, A_wo)
    x = x + _B_ref(_layernorm(x, axis=-1), B_w_gate, B_w_up, B_w_down)
    return x
```

```asm
; @launch grid=(256,1,1) block=(512,1,1) lds=163840
.amdgcn_target "amdgcn-amd-amdhsa--gfx950"
.text
    .globl interleave_layers__mha_block__glu_gated_bilinear__prompt_kernel
    .p2align 8
    .type interleave_layers__mha_block__glu_gated_bilinear__prompt_kernel,@function
interleave_layers__mha_block__glu_gated_bilinear__prompt_kernel:
    s_cmp_ge_u32 s2, 256
    s_cbranch_scc1 L_end_1
    s_load_dwordx16 s[36:51], s[0:1], 0
    s_load_dwordx4 s[52:55], s[0:1], 64
    s_getpc_b64 s[60:61]
L_pc0:
    s_lshr_b32 s19, s2, 3
    s_lshl_b32 s62, s19, 11
    s_min_u32 s62, s62, L_code_end - L_pc0 - 2048
    v_lshl_add_u32 v2, v0, 2, s62
    global_load_dword v240, v2, s[60:61]
    v_and_b32 v1, 63, v0
    v_lshrrev_b32 v2, 6, v0
    v_lshlrev_b32 v3, 4, v1
    v_readfirstlane_b32 s16, v2
    s_getreg_b32 s70, hwreg(HW_REG_XCC_ID, 0, 4)
    s_mov_b32 s22, 0
    s_mov_b32 s20, 0
    s_mov_b32 s24, 0
    s_and_b32 s18, s70, 7
    s_and_b32 s30, s16, 3
    s_lshl_b32 s30, s30, 10
    s_mov_b32 s58, 2097152
    s_mov_b32 s59, 0x00020000
    s_mov_b32 s82, 1572864
    s_mov_b32 s83, 0x00020000
    s_waitcnt lgkmcnt(0)
    s_mov_b32 s56, s36
    s_mov_b32 s57, s37
    s_mov_b32 s80, s38
    s_mov_b32 s81, s39
L_roles_2:
    s_cmp_lt_u32 s16, 4
    s_cbranch_scc1 L_cp_3
    v_lshrrev_b32 v2, 2, v1
    v_mul_u32_u24 v24, 3072, v2
    v_and_b32 v2, 3, v1
    v_lshl_add_u32 v24, v2, 4, v24
    v_and_b32 v2, 7, v1
    v_lshrrev_b32 v27, 4, v1
    v_xor_b32 v2, v2, v27
    v_lshlrev_b32 v2, 4, v2
    v_lshrrev_b32 v27, 3, v1
    v_lshl_add_u32 v25, v27, 10, v2
    v_xor_b32 v26, 64, v25
    s_lshl_b32 s4, s18, 3
    s_and_b32 s7, s19, 1
    s_lshl_b32 s5, s7, 2
    s_add_u32 s4, s4, s5
    s_lshl_b32 s4, s4, 15
    s_lshl_b32 s5, s30, 5
    s_add_u32 s4, s4, s5
    s_lshr_b32 s5, s19, 1
    s_lshl_b32 s5, s5, 6
    s_mul_i32 s6, s30, 48
    s_add_u32 s5, s5, s6
    s_mul_i32 s32, s30, 3
    s_lshl_b32 s33, s30, 2
    s_add_u32 s61, s18, 0
    s_and_b32 s61, s61, 7
    s_mul_i32 s60, s61, 196608
    s_add_u32 s60, s60, s5
    s_add_u32 m0, s32, 0
    s_lshl_b32 s61, s61, 7
    s_add_u32 s61, s61, s4
    buffer_load_dwordx4 v24, s[80:83], s60 offen offset:1024 lds
    buffer_load_dwordx4 v24, s[80:83], s60 offen offset:2048 lds
    buffer_load_dwordx4 v24, s[80:83], s60 offen offset:0 lds
    s_add_u32 m0, s33, 12288
    s_add_u32 s60, s61, 0
    buffer_load_dwordx4 v25, s[56:59], s60 offen offset:0 lds
    s_add_u32 s60, s61, 7168
    buffer_load_dwordx4 v26, s[56:59], s60 offen offset:1024 lds
    s_add_u32 s60, s61, 14336
    buffer_load_dwordx4 v25, s[56:59], s60 offen offset:2048 lds
    s_add_u32 s60, s61, 21504
    buffer_load_dwordx4 v26, s[56:59], s60 offen offset:3072 lds
    s_add_u32 s61, s18, 1
    s_and_b32 s61, s61, 7
    s_mul_i32 s60, s61, 196608
    s_add_u32 s60, s60, s5
    s_add_u32 m0, s32, 28672
    s_lshl_b32 s61, s61, 7
    s_add_u32 s61, s61, s4
    buffer_load_dwordx4 v24, s[80:83], s60 offen offset:1024 lds
    buffer_load_dwordx4 v24, s[80:83], s60 offen offset:2048 lds
    buffer_load_dwordx4 v24, s[80:83], s60 offen offset:0 lds
    s_add_u32 m0, s33, 40960
    s_add_u32 s60, s61, 0
    buffer_load_dwordx4 v25, s[56:59], s60 offen offset:0 lds
    s_add_u32 s60, s61, 7168
    buffer_load_dwordx4 v26, s[56:59], s60 offen offset:1024 lds
    s_add_u32 s60, s61, 14336
    buffer_load_dwordx4 v25, s[56:59], s60 offen offset:2048 lds
    s_add_u32 s60, s61, 21504
    buffer_load_dwordx4 v26, s[56:59], s60 offen offset:3072 lds
    s_cmp_lg_u32 s20, 0
    s_cbranch_scc1 L_p5_5
    s_mov_b32 s8, s54
    s_mov_b32 s9, s55
    s_mov_b32 s10, 0x5000000
    s_mov_b32 s11, 0x00020000
    s_mov_b32 s12, s50
    s_mov_b32 s13, s51
    s_mov_b32 s14, 0x200000
    s_mov_b32 s15, 0x00020000
    s_mov_b32 s84, s52
    s_mov_b32 s85, s53
    s_mov_b32 s86, 0x100
    s_mov_b32 s87, 0x00020000
    v_add_u32 v4, 0x10000, v3
    v_add_u32 v5, 0x20000, v3
    v_lshlrev_b32 v6, 2, v1
    v_mov_b32 v7, 0
    s_mov_b32 s23, 0
    s_mov_b32 s25, 1
    s_lshl_b32 s17, s16, 10
    v_mov_b32 v0, 163824
    v_lshlrev_b32 v254, 5, v1
    s_lshr_b32 s60, s30, 8
    v_mov_b32 v253, s60
    s_mov_b32 s78, 0
    s_lshl_b32 s71, s18, 5
    s_cmp_lg_u32 s16, 0
    s_cbranch_scc1 L_p5_5
    ds_write_b32 v0, v7
    ds_write_b32 v0, v7 offset:4
    s_and_b32 s72, s2, 127
    s_lshl_b32 s72, s72, 7
    s_add_u32 s72, s72, 54591488
    s_mov_b32 exec_hi, 0
    buffer_store_dword v7, v6, s[8:11], s72 offen sc1
    s_mov_b64 exec, -1
L_p5_5:
    s_lshl_b32 s31, s18, 10
    s_add_u32 s31, s31, 54591488
    s_lshl_b32 s21, s19, 5
    s_add_u32 s21, s21, s31
    s_lshr_b32 s76, s19, 1
    s_mul_i32 s26, s76, 98304
    s_add_u32 s26, s26, 58720256
    s_mov_b32 s3, 0
    s_mov_b32 s77, 71303168
    s_mul_i32 s79, s22, 18874368
    s_add_u32 s79, s79, 2097152
    s_mul_i32 s88, s22, 20709376
    s_add_u32 s88, s88, 19136512
    s_min_u32 s76, s76, 14
    s_mul_i32 s28, s76, 196608
    s_add_u32 s28, s28, 49283072
    s_lshr_b32 s76, s19, 2
    s_lshl_b32 s27, s76, 16
    s_add_u32 s27, s27, 48234496
    s_mul_i32 s29, s76, 176128
    s_add_u32 s29, s29, 52428800
    v_mov_b32 v28, v24
    v_mov_b32 v29, v25
    v_mov_b32 v30, v26
    v_and_b32 v24, 31, v1
    v_lshrrev_b32 v25, 5, v1
    v_bfe_u32 v26, v1, 1, 3
    v_xor_b32 v25, v25, v26
    v_lshlrev_b32 v25, 4, v25
    v_lshl_add_u32 v25, v24, 7, v25
    s_lshl_b32 s60, s30, 2
    s_add_u32 s60, s60, 12288
    v_add_u32 v25, s60, v25
    v_xor_b32 v8, 0, v25
    v_add_u32 v9, 0x10000, v8
    v_add_u32 v10, 0x20000, v8
    v_xor_b32 v11, 32, v25
    v_add_u32 v12, 0x10000, v11
    v_add_u32 v13, 0x20000, v11
    v_xor_b32 v14, 64, v25
    v_add_u32 v15, 0x10000, v14
    v_add_u32 v16, 0x20000, v14
    v_xor_b32 v17, 96, v25
    v_add_u32 v18, 0x10000, v17
    v_add_u32 v19, 0x20000, v17
    v_lshrrev_b32 v2, 5, v1
    v_lshlrev_b32 v20, 8, v2
    v_bfe_u32 v2, v1, 2, 2
    v_lshl_add_u32 v20, v2, 6, v20
    v_bfe_u32 v2, v1, 4, 1
    v_lshl_add_u32 v20, v2, 5, v20
    v_and_b32 v2, 3, v1
    v_lshl_add_u32 v20, v2, 3, v20
    s_mul_i32 s60, s30, 3
    v_add_u32 v20, s60, v20
    v_add_u32 v21, 0x10000, v20
    v_add_u32 v22, 0x20000, v20
    v_mov_b32 v24, v28
    v_mov_b32 v25, v29
    v_mov_b32 v26, v30
    v_mov_b32 v60, 0x3f803f80
    v_mov_b32 v61, 0x3f803f80
    v_mov_b32 v62, 0x3f803f80
    v_mov_b32 v63, 0x3f803f80
    s_waitcnt vmcnt(7)
    s_barrier
    s_add_u32 s61, s18, 2
    s_and_b32 s61, s61, 7
    s_mul_i32 s60, s61, 196608
    s_add_u32 s60, s60, s5
    s_add_u32 m0, s32, 57344
    s_lshl_b32 s61, s61, 7
    s_add_u32 s61, s61, s4
    buffer_load_dwordx4 v24, s[80:83], s60 offen offset:1024 lds
    buffer_load_dwordx4 v24, s[80:83], s60 offen offset:2048 lds
    buffer_load_dwordx4 v24, s[80:83], s60 offen offset:0 lds
    s_add_u32 m0, s33, 69632
    s_add_u32 s60, s61, 0
    buffer_load_dwordx4 v25, s[56:59], s60 offen offset:0 lds
    s_add_u32 s60, s61, 7168
    buffer_load_dwordx4 v26, s[56:59], s60 offen offset:1024 lds
    s_add_u32 s60, s61, 14336
    buffer_load_dwordx4 v25, s[56:59], s60 offen offset:2048 lds
    s_add_u32 s60, s61, 21504
    buffer_load_dwordx4 v26, s[56:59], s60 offen offset:3072 lds
    s_add_u32 s61, s18, 3
    s_and_b32 s61, s61, 7
    s_mul_i32 s60, s61, 196608
    s_add_u32 s60, s60, s5
    s_add_u32 m0, s32, 86016
    s_lshl_b32 s61, s61, 7
    s_add_u32 s61, s61, s4
    buffer_load_dwordx4 v24, s[80:83], s60 offen offset:1024 lds
    buffer_load_dwordx4 v24, s[80:83], s60 offen offset:2048 lds
    buffer_load_dwordx4 v24, s[80:83], s60 offen offset:0 lds
    s_add_u32 m0, s33, 98304
    s_add_u32 s60, s61, 0
    buffer_load_dwordx4 v25, s[56:59], s60 offen offset:0 lds
    s_add_u32 s60, s61, 7168
    buffer_load_dwordx4 v26, s[56:59], s60 offen offset:1024 lds
    s_add_u32 s60, s61, 14336
    buffer_load_dwordx4 v25, s[56:59], s60 offen offset:2048 lds
    s_add_u32 s60, s61, 21504
    buffer_load_dwordx4 v26, s[56:59], s60 offen offset:3072 lds
    ds_read_b64_tr_b16 v[32:33], v20 offset:0
    ds_read_b64_tr_b16 v[34:35], v20 offset:512
    ds_read_b64_tr_b16 v[36:37], v20 offset:1024
    ds_read_b64_tr_b16 v[38:39], v20 offset:1536
    ds_read_b64_tr_b16 v[40:41], v20 offset:2048
    ds_read_b64_tr_b16 v[42:43], v20 offset:2560
    s_waitcnt lgkmcnt(0)
    v_mfma_f32_32x32x16_bf16 v[64:79], v[60:63], v[32:35], 0
    v_mfma_f32_32x32x16_bf16 v[80:95], v[60:63], v[36:39], 0
    v_mfma_f32_32x32x16_bf16 v[96:111], v[60:63], v[40:43], 0
    s_waitcnt vmcnt(14)
    s_barrier
    s_add_u32 s61, s18, 4
    s_and_b32 s61, s61, 7
    s_mul_i32 s60, s61, 196608
    s_add_u32 s60, s60, s5
    s_add_u32 m0, s32, 114688
    s_lshl_b32 s61, s61, 7
    s_add_u32 s61, s61, s4
    buffer_load_dwordx4 v24, s[80:83], s60 offen offset:1024 lds
    buffer_load_dwordx4 v24, s[80:83], s60 offen offset:2048 lds
    buffer_load_dwordx4 v24, s[80:83], s60 offen offset:0 lds
    s_add_u32 m0, s33, 126976
    s_add_u32 s60, s61, 0
    buffer_load_dwordx4 v25, s[56:59], s60 offen offset:0 lds
    s_add_u32 s60, s61, 7168
    buffer_load_dwordx4 v26, s[56:59], s60 offen offset:1024 lds
    s_add_u32 s60, s61, 14336
    buffer_load_dwordx4 v25, s[56:59], s60 offen offset:2048 lds
    s_add_u32 s60, s61, 21504
    buffer_load_dwordx4 v26, s[56:59], s60 offen offset:3072 lds
    ds_read_b64_tr_b16 v[32:33], v20 offset:28672
    ds_read_b64_tr_b16 v[34:35], v20 offset:29184
    ds_read_b64_tr_b16 v[36:37], v20 offset:29696
    ds_read_b64_tr_b16 v[38:39], v20 offset:30208
    ds_read_b64_tr_b16 v[40:41], v20 offset:30720
    ds_read_b64_tr_b16 v[42:43], v20 offset:31232
    s_waitcnt lgkmcnt(0)
    v_mfma_f32_32x32x16_bf16 v[64:79], v[60:63], v[32:35], v[64:79]
    v_mfma_f32_32x32x16_bf16 v[80:95], v[60:63], v[36:39], v[80:95]
    v_mfma_f32_32x32x16_bf16 v[96:111], v[60:63], v[40:43], v[96:111]
    s_waitcnt vmcnt(14)
    s_barrier
    v_lshlrev_b32 v120, 5, v1
    s_mov_b64 exec, 0xff
    buffer_load_dwordx2 v[122:123], v120, s[84:87], 0 offen sc1
    s_mov_b64 exec, -1
    s_add_u32 s61, s18, 5
    s_and_b32 s61, s61, 7
    s_mul_i32 s60, s61, 196608
    s_add_u32 s60, s60, s5
    s_add_u32 m0, s32, 0
    s_lshl_b32 s61, s61, 7
    s_add_u32 s61, s61, s4
    buffer_load_dwordx4 v24, s[80:83], s60 offen offset:1024 lds
    buffer_load_dwordx4 v24, s[80:83], s60 offen offset:2048 lds
    buffer_load_dwordx4 v24, s[80:83], s60 offen offset:0 lds
    s_add_u32 m0, s33, 12288
    s_add_u32 s60, s61, 0
    buffer_load_dwordx4 v25, s[56:59], s60 offen offset:0 lds
    s_add_u32 s60, s61, 7168
    buffer_load_dwordx4 v26, s[56:59], s60 offen offset:1024 lds
    s_add_u32 s60, s61, 14336
    buffer_load_dwordx4 v25, s[56:59], s60 offen offset:2048 lds
    s_add_u32 s60, s61, 21504
    buffer_load_dwordx4 v26, s[56:59], s60 offen offset:3072 lds
    ds_read_b64_tr_b16 v[32:33], v20 offset:57344
    ds_read_b64_tr_b16 v[34:35], v20 offset:57856
    ds_read_b64_tr_b16 v[36:37], v20 offset:58368
    ds_read_b64_tr_b16 v[38:39], v20 offset:58880
    ds_read_b64_tr_b16 v[40:41], v20 offset:59392
    ds_read_b64_tr_b16 v[42:43], v20 offset:59904
    s_waitcnt lgkmcnt(0)
    v_mfma_f32_32x32x16_bf16 v[64:79], v[60:63], v[32:35], v[64:79]
    v_mfma_f32_32x32x16_bf16 v[80:95], v[60:63], v[36:39], v[80:95]
    v_mfma_f32_32x32x16_bf16 v[96:111], v[60:63], v[40:43], v[96:111]
    s_waitcnt vmcnt(15)
    s_barrier
    s_add_u32 s61, s18, 6
    s_and_b32 s61, s61, 7
    s_mul_i32 s60, s61, 196608
    s_add_u32 s60, s60, s5
    s_add_u32 m0, s32, 28672
    s_lshl_b32 s61, s61, 7
    s_add_u32 s61, s61, s4
    buffer_load_dwordx4 v24, s[80:83], s60 offen offset:1024 lds
    buffer_load_dwordx4 v24, s[80:83], s60 offen offset:2048 lds
    buffer_load_dwordx4 v24, s[80:83], s60 offen offset:0 lds
    s_add_u32 m0, s33, 40960
    s_add_u32 s60, s61, 0
    buffer_load_dwordx4 v25, s[56:59], s60 offen offset:0 lds
    s_add_u32 s60, s61, 7168
    buffer_load_dwordx4 v26, s[56:59], s60 offen offset:1024 lds
    s_add_u32 s60, s61, 14336
    buffer_load_dwordx4 v25, s[56:59], s60 offen offset:2048 lds
    s_add_u32 s60, s61, 21504
    buffer_load_dwordx4 v26, s[56:59], s60 offen offset:3072 lds
    s_cmp_lg_u32 s16, 4
    s_cbranch_scc1 L_w4s_6
    s_waitcnt vmcnt(14)
    s_cmp_lg_u32 s20, 0
    s_cbranch_scc1 L_tk_7
    s_mov_b32 s60, 0
    s_mov_b64 exec, 0xff
    v_cmp_ne_u32 vcc, 0x2000, v123
    v_cmp_ne_u32 s[62:63], -1, v122
    s_nop 1
    s_or_b64 s[62:63], s[62:63], vcc
    s_cmp_eq_u64 s[62:63], 0
    s_cbranch_scc1 L_tkd_9f
L_tkp_8:
    s_add_u32 s60, s60, 1
    v_bfe_u32 v121, v123, 8, 16
    s_nop 0
    v_readlane_b32 s62, v121, 0
    v_readlane_b32 s63, v121, 1
    s_add_u32 s62, s62, s63
    v_readlane_b32 s63, v121, 2
    s_add_u32 s62, s62, s63
    v_readlane_b32 s63, v121, 3
    s_add_u32 s62, s62, s63
    v_readlane_b32 s63, v121, 4
    s_add_u32 s62, s62, s63
    v_readlane_b32 s63, v121, 5
    s_add_u32 s62, s62, s63
    v_readlane_b32 s63, v121, 6
    s_add_u32 s62, s62, s63
    v_readlane_b32 s63, v121, 7
    s_add_u32 s62, s62, s63
    s_cmp_gt_u32 s60, 0x4000
    s_cbranch_scc1 L_tkd_9
    s_cmp_ge_u32 s62, 256
    s_cbranch_scc1 L_tkd_9
    buffer_load_dwordx2 v[122:123], v120, s[84:87], 0 offen sc1
    s_waitcnt vmcnt(0)
    s_branch L_tkp_8
L_tkd_9:
    v_and_b32 v2, 0xffffff00, v123
    v_cmp_ne_u32 vcc, 0x2000, v2
    v_cmp_ne_u32 s[62:63], -1, v122
    v_cmp_ne_u32 s[64:65], v2, v123
    s_nop 2
    s_or_b64 s[62:63], s[62:63], s[64:65]
    s_cmp_lg_u64 s[62:63], 0
    s_cselect_b32 s60, 1, 0
    s_cmp_lg_u64 vcc, 0
    s_cselect_b32 s60, 2, s60
L_tkd_9f:
    s_mov_b64 exec, -1
    v_mov_b32 v2, s60
    v_mov_b32 v120, 143360
    ds_write_b32 v120, v2
    s_waitcnt lgkmcnt(0)
    s_cmp_lg_u32 s60, 0
    s_cbranch_scc1 L_tkn_10
L_tk_7:
    s_add_u32 s61, s25, 0
    s_mov_b64 exec, 15
    v_mov_b32 v2, s61
    s_cmp_lg_u32 s22, 0
    s_cbranch_scc1 L_sts_11
    buffer_store_dword v2, v6, s[8:11], s21 offen
L_std_12:
    s_mov_b64 exec, -1
L_tkn_10:
L_w4s_6:
    ds_read_b64_tr_b16 v[32:33], v21 offset:20480
    ds_read_b64_tr_b16 v[34:35], v21 offset:20992
    ds_read_b64_tr_b16 v[36:37], v21 offset:21504
    ds_read_b64_tr_b16 v[38:39], v21 offset:22016
    ds_read_b64_tr_b16 v[40:41], v21 offset:22528
    ds_read_b64_tr_b16 v[42:43], v21 offset:23040
    s_waitcnt lgkmcnt(0)
    v_mfma_f32_32x32x16_bf16 v[64:79], v[60:63], v[32:35], v[64:79]
    v_mfma_f32_32x32x16_bf16 v[80:95], v[60:63], v[36:39], v[80:95]
    v_mfma_f32_32x32x16_bf16 v[96:111], v[60:63], v[40:43], v[96:111]
    s_waitcnt vmcnt(15)
    s_barrier
    v_mov_b32 v2, 143360
    ds_read_b64 v[30:31], v2
    s_add_u32 s61, s18, 7
    s_and_b32 s61, s61, 7
    s_mul_i32 s60, s61, 196608
    s_add_u32 s60, s60, s5
    s_add_u32 m0, s32, 57344
    s_lshl_b32 s61, s61, 7
    s_add_u32 s61, s61, s4
    buffer_load_dwordx4 v24, s[80:83], s60 offen offset:1024 lds
    buffer_load_dwordx4 v24, s[80:83], s60 offen offset:2048 lds
    buffer_load_dwordx4 v24, s[80:83], s60 offen offset:0 lds
    s_add_u32 m0, s33, 69632
    s_add_u32 s60, s61, 0
    buffer_load_dwordx4 v25, s[56:59], s60 offen offset:0 lds
    s_add_u32 s60, s61, 7168
    buffer_load_dwordx4 v26, s[56:59], s60 offen offset:1024 lds
    s_add_u32 s60, s61, 14336
    buffer_load_dwordx4 v25, s[56:59], s60 offen offset:2048 lds
    s_add_u32 s60, s61, 21504
    buffer_load_dwordx4 v26, s[56:59], s60 offen offset:3072 lds
    ds_read_b64_tr_b16 v[32:33], v21 offset:49152
    ds_read_b64_tr_b16 v[34:35], v21 offset:49664
    ds_read_b64_tr_b16 v[36:37], v21 offset:50176
    ds_read_b64_tr_b16 v[38:39], v21 offset:50688
    ds_read_b64_tr_b16 v[40:41], v21 offset:51200
    ds_read_b64_tr_b16 v[42:43], v21 offset:51712
    s_waitcnt lgkmcnt(0)
    v_mfma_f32_32x32x16_bf16 v[64:79], v[60:63], v[32:35], v[64:79]
    v_mfma_f32_32x32x16_bf16 v[80:95], v[60:63], v[36:39], v[80:95]
    v_mfma_f32_32x32x16_bf16 v[96:111], v[60:63], v[40:43], v[96:111]
    s_waitcnt vmcnt(14)
    s_barrier
    v_readfirstlane_b32 s60, v30
    s_andn2_b32 s60, s60, s20
    s_mov_b32 s20, 3
    s_cmp_eq_u32 s60, 0
    s_cbranch_scc1 L_valid_13
    v_readfirstlane_b32 s61, v31
    s_waitcnt vmcnt(0) lgkmcnt(0)
    s_nop 15
    s_barrier
    s_mov_b32 s19, s61
    s_cmp_eq_u32 s60, 1
    s_cbranch_scc1 L_roles_2
    s_and_b32 s18, s2, 7
    s_lshr_b32 s19, s2, 3
    s_mov_b32 s22, 1
    s_branch L_roles_2
L_valid_13:
    s_lshl_b32 s63, s7, 4
    s_lshl_b32 s63, 0xffff, s63
    s_mov_b32 exec_lo, s63
    s_mov_b32 exec_hi, 0
    buffer_load_dwordx4 v[124:127], v254, s[8:11], s31 offen sc1
    s_mov_b64 exec, -1
    ds_read_b64_tr_b16 v[32:33], v20 offset:0
    ds_read_b64_tr_b16 v[34:35], v20 offset:512
    ds_read_b64_tr_b16 v[36:37], v20 offset:1024
    ds_read_b64_tr_b16 v[38:39], v20 offset:1536
    ds_read_b64_tr_b16 v[40:41], v20 offset:2048
    ds_read_b64_tr_b16 v[42:43], v20 offset:2560
    s_waitcnt lgkmcnt(0)
    v_mfma_f32_32x32x16_bf16 v[64:79], v[60:63], v[32:35], v[64:79]
    v_mfma_f32_32x32x16_bf16 v[80:95], v[60:63], v[36:39], v[80:95]
    v_mfma_f32_32x32x16_bf16 v[96:111], v[60:63], v[40:43], v[96:111]
    s_waitcnt vmcnt(8)
    s_cmp_lg_u32 s16, 4
    s_cbranch_scc1 L_w4_14
    s_mov_b32 s62, 1
    s_waitcnt vmcnt(0)
    s_mov_b32 exec_lo, s63
    s_mov_b32 exec_hi, 0
    v_min3_u32 v124, v124, v125, v126
    v_min_u32 v124, v124, v127
    v_cmp_gt_u32 vcc, 1, v124
    s_mov_b64 exec, -1
    s_nop 0
    s_cbranch_vccz L_w4_14
    s_mov_b32 exec_lo, s63
    s_mov_b32 exec_hi, 0
    s_mov_b32 s60, 0
    buffer_load_dwordx4 v[244:247], v254, s[8:11], s31 offen sc1
L_poll_15:
    buffer_load_dwordx4 v[248:251], v254, s[8:11], s31 offen sc1
    s_waitcnt vmcnt(1)
    v_min3_u32 v244, v244, v245, v246
    v_min_u32 v244, v244, v247
    v_cmp_gt_u32 vcc, s62, v244
    s_add_u32 s60, s60, 1
    s_cmp_gt_u32 s60, 0x4000
    s_cbranch_vccz L_polld_16
    buffer_load_dwordx4 v[244:247], v254, s[8:11], s31 offen sc1
    s_waitcnt vmcnt(1)
    v_min3_u32 v248, v248, v249, v250
    v_min_u32 v248, v248, v251
    v_cmp_gt_u32 vcc, s62, v248
    s_cbranch_scc1 L_polld_16
    s_nop 0
    s_cbranch_vccnz L_poll_15
L_polld_16:
    s_mov_b64 exec, -1
L_w4_14:
    s_barrier
    ds_read_b64_tr_b16 v[32:33], v20 offset:28672
    ds_read_b64_tr_b16 v[34:35], v20 offset:29184
    ds_read_b64_tr_b16 v[36:37], v20 offset:29696
    ds_read_b64_tr_b16 v[38:39], v20 offset:30208
    ds_read_b64_tr_b16 v[40:41], v20 offset:30720
    ds_read_b64_tr_b16 v[42:43], v20 offset:31232
    s_waitcnt lgkmcnt(0)
    v_mfma_f32_32x32x16_bf16 v[64:79], v[60:63], v[32:35], v[64:79]
    v_mfma_f32_32x32x16_bf16 v[80:95], v[60:63], v[36:39], v[80:95]
    v_mfma_f32_32x32x16_bf16 v[96:111], v[60:63], v[40:43], v[96:111]
    s_waitcnt vmcnt(1)
    s_barrier
    ds_read_b64_tr_b16 v[32:33], v20 offset:57344
    ds_read_b64_tr_b16 v[34:35], v20 offset:57856
    ds_read_b64_tr_b16 v[36:37], v20 offset:58368
    ds_read_b64_tr_b16 v[38:39], v20 offset:58880
    ds_read_b64_tr_b16 v[40:41], v20 offset:59392
    ds_read_b64_tr_b16 v[42:43], v20 offset:59904
    s_waitcnt lgkmcnt(0)
    v_mfma_f32_32x32x16_bf16 v[64:79], v[60:63], v[32:35], v[64:79]
    v_mfma_f32_32x32x16_bf16 v[80:95], v[60:63], v[36:39], v[80:95]
    v_mfma_f32_32x32x16_bf16 v[96:111], v[60:63], v[40:43], v[96:111]
    s_lshr_b32 s60, s30, 8
    v_and_b32 v117, 31, v1
    v_lshl_add_u32 v117, v117, 4, s60
    v_add_u32 v118, 145408, v117
    s_nop 7
    s_nop 7
    v_cvt_pk_bf16_f32 v119, v64, v64
    v_and_b32 v114, 0xffff0000, v119
    v_sub_f32 v114, v64, v114
    v_cvt_pk_bf16_f32 v119, v64, v114
    v_cvt_pk_bf16_f32 v120, v80, v80
    v_and_b32 v114, 0xffff0000, v120
    v_sub_f32 v114, v80, v114
    v_cvt_pk_bf16_f32 v120, v80, v114
    v_cvt_pk_bf16_f32 v121, v96, v96
    v_and_b32 v114, 0xffff0000, v121
    v_sub_f32 v114, v96, v114
    v_cvt_pk_bf16_f32 v121, v96, v114
    s_mov_b32 exec_lo, -1
    s_mov_b32 exec_hi, 0
    ds_write_b32 v118, v119 offset:0
    ds_write_b32 v118, v120 offset:512
    ds_write_b32 v118, v121 offset:1024
    s_mov_b64 exec, -1
    s_waitcnt lgkmcnt(0)
    s_barrier
    s_add_u32 s78, s78, 4
    s_branch L_se_4
L_cp_3:
    s_cmp_lg_u32 s20, 0
    s_cbranch_scc1 L_p5_17
    s_mov_b32 s8, s54
    s_mov_b32 s9, s55
    s_mov_b32 s10, 0x5000000
    s_mov_b32 s11, 0x00020000
    s_mov_b32 s12, s50
    s_mov_b32 s13, s51
    s_mov_b32 s14, 0x200000
    s_mov_b32 s15, 0x00020000
    s_mov_b32 s84, s52
    s_mov_b32 s85, s53
    s_mov_b32 s86, 0x100
    s_mov_b32 s87, 0x00020000
    v_add_u32 v4, 0x10000, v3
    v_add_u32 v5, 0x20000, v3
    v_lshlrev_b32 v6, 2, v1
    v_mov_b32 v7, 0
    s_mov_b32 s23, 0
    s_mov_b32 s25, 1
    s_lshl_b32 s17, s16, 10
    v_mov_b32 v0, 163824
    v_lshlrev_b32 v254, 5, v1
    s_lshr_b32 s60, s30, 8
    v_mov_b32 v253, s60
    s_mov_b32 s78, 0
    s_lshl_b32 s71, s18, 5
    s_cmp_lg_u32 s16, 0
    s_cbranch_scc1 L_p5_17
    ds_write_b32 v0, v7
    ds_write_b32 v0, v7 offset:4
    s_and_b32 s72, s2, 127
    s_lshl_b32 s72, s72, 7
    s_add_u32 s72, s72, 54591488
    s_mov_b32 exec_hi, 0
    buffer_store_dword v7, v6, s[8:11], s72 offen sc1
    s_mov_b64 exec, -1
L_p5_17:
    s_lshl_b32 s31, s18, 10
    s_add_u32 s31, s31, 54591488
    s_lshl_b32 s21, s19, 5
    s_add_u32 s21, s21, s31
    s_lshr_b32 s76, s19, 1
    s_mul_i32 s26, s76, 98304
    s_add_u32 s26, s26, 58720256
    s_mov_b32 s3, 0
    s_mov_b32 s77, 71303168
    s_mul_i32 s79, s22, 18874368
    s_add_u32 s79, s79, 2097152
    s_mul_i32 s88, s22, 20709376
    s_add_u32 s88, s88, 19136512
    s_min_u32 s76, s76, 14
    s_mul_i32 s28, s76, 196608
    s_add_u32 s28, s28, 49283072
    s_lshr_b32 s76, s19, 2
    s_lshl_b32 s27, s76, 16
    s_add_u32 s27, s27, 48234496
    s_mul_i32 s29, s76, 176128
    s_add_u32 s29, s29, 52428800
    v_lshrrev_b32 v2, 3, v1
    v_and_b32 v8, 7, v1
    v_lshlrev_b32 v8, 4, v8
    v_lshl_add_u32 v8, v2, 10, v8
    s_lshl_b32 s62, s18, 18
    s_lshl_b32 s63, s19, 13
    s_add_u32 s62, s62, s63
    s_lshl_b32 s63, s16, 8
    s_add_u32 s62, s62, s63
    buffer_load_dwordx4 v[32:35], v8, s[56:59], s62 offen
    buffer_load_dwordx4 v[36:39], v8, s[56:59], s62 offen offset:128
    s_or_b32 s60, s16, s20
    s_cmp_lg_u32 s60, 0
    s_cbranch_scc1 L_wm_18
    s_lshl_b32 s72, 1, s19
    s_lshr_b32 s73, s70, 3
    s_cmp_lg_u32 s73, 0
    s_cselect_b32 s73, 0x01000000, 0
    s_or_b32 s73, s73, 0x100
    v_mov_b32 v200, s72
    v_mov_b32 v201, s73
    s_mov_b64 exec, 1
    s_waitcnt vmcnt(2)
    buffer_atomic_add_x2 v[200:201], v7, s[84:87], s71 offen sc0 sc1
    s_mov_b64 exec, -1
L_wm_18:
    s_lshl_b32 s60, s18, 3
    s_lshr_b32 s61, s19, 2
    s_add_u32 s60, s60, s61
    s_lshl_b32 s60, s60, 12
    s_add_u32 s60, s60, s17
    s_and_b32 s61, s19, 3
    s_lshl_b32 s61, s61, 7
    s_add_u32 s60, s60, s61
    s_add_u32 s67, s60, 18874368
    v_lshrrev_b32 v9, 3, v1
    v_lshlrev_b32 v9, 4, v9
    v_bfe_u32 v10, v1, 2, 1
    v_lshl_add_u32 v9, v10, 2, v9
    v_bfe_u32 v10, v1, 1, 1
    v_lshl_add_u32 v9, v10, 3, v9
    v_cmp_eq_u32 s[64:65], 1, v10
    v_and_b32 v10, 1, v1
    v_lshl_add_u32 v9, v10, 9, v9
    v_cmp_eq_u32 s[68:69], 1, v10
    s_waitcnt vmcnt(1)
    s_or_b32 s60, s16, s20
    s_cmp_eq_u32 s60, 0
    s_cbranch_scc1 L_xw_19
    s_waitcnt vmcnt(0)
L_xw_19:
    v_mov_b32 v40, 0
    v_mov_b32 v41, 0
    v_lshlrev_b32 v44, 16, v32
    v_and_b32 v45, 0xffff0000, v32
    v_add_f32 v40, v40, v44
    v_fmac_f32 v41, v44, v44
    v_add_f32 v40, v40, v45
    v_fmac_f32 v41, v45, v45
    v_lshlrev_b32 v44, 16, v33
    v_and_b32 v45, 0xffff0000, v33
    v_add_f32 v40, v40, v44
    v_fmac_f32 v41, v44, v44
    v_add_f32 v40, v40, v45
    v_fmac_f32 v41, v45, v45
    v_lshlrev_b32 v44, 16, v34
    v_and_b32 v45, 0xffff0000, v34
    v_add_f32 v40, v40, v44
    v_fmac_f32 v41, v44, v44
    v_add_f32 v40, v40, v45
    v_fmac_f32 v41, v45, v45
    v_lshlrev_b32 v44, 16, v35
    v_and_b32 v45, 0xffff0000, v35
    v_add_f32 v40, v40, v44
    v_fmac_f32 v41, v44, v44
    v_add_f32 v40, v40, v45
    v_fmac_f32 v41, v45, v45
    v_mov_b32 v42, 0
    v_mov_b32 v43, 0
    v_lshlrev_b32 v44, 16, v36
    v_and_b32 v45, 0xffff0000, v36
    v_add_f32 v42, v42, v44
    v_fmac_f32 v43, v44, v44
    v_add_f32 v42, v42, v45
    v_fmac_f32 v43, v45, v45
    v_lshlrev_b32 v44, 16, v37
    v_and_b32 v45, 0xffff0000, v37
    v_add_f32 v42, v42, v44
    v_fmac_f32 v43, v44, v44
    v_add_f32 v42, v42, v45
    v_fmac_f32 v43, v45, v45
    v_lshlrev_b32 v44, 16, v38
    v_and_b32 v45, 0xffff0000, v38
    v_add_f32 v42, v42, v44
    v_fmac_f32 v43, v44, v44
    v_add_f32 v42, v42, v45
    v_fmac_f32 v43, v45, v45
    v_lshlrev_b32 v44, 16, v39
    v_and_b32 v45, 0xffff0000, v39
    v_add_f32 v42, v42, v44
    v_fmac_f32 v43, v44, v44
    v_add_f32 v42, v42, v45
    v_fmac_f32 v43, v45, v45
    s_nop 1
    v_add_f32_dpp v40, v40, v40 quad_perm:[1,0,3,2] row_mask:0xf bank_mask:0xf
    v_add_f32_dpp v41, v41, v41 quad_perm:[1,0,3,2] row_mask:0xf bank_mask:0xf
    v_add_f32_dpp v42, v42, v42 quad_perm:[1,0,3,2] row_mask:0xf bank_mask:0xf
    v_add_f32_dpp v43, v43, v43 quad_perm:[1,0,3,2] row_mask:0xf bank_mask:0xf
    s_nop 0
    v_add_f32_dpp v40, v40, v40 quad_perm:[2,3,0,1] row_mask:0xf bank_mask:0xf
    v_add_f32_dpp v41, v41, v41 quad_perm:[2,3,0,1] row_mask:0xf bank_mask:0xf
    v_add_f32_dpp v42, v42, v42 quad_perm:[2,3,0,1] row_mask:0xf bank_mask:0xf
    v_add_f32_dpp v43, v43, v43 quad_perm:[2,3,0,1] row_mask:0xf bank_mask:0xf
    s_nop 0
    v_cndmask_b32 v40, v40, v41, s[68:69]
    v_cndmask_b32 v42, v42, v43, s[68:69]
    v_cndmask_b32 v40, v40, v42, s[64:65]
    buffer_store_dword v40, v9, s[8:11], s67 offen sc1
    v_and_b32 v24, 31, v1
    v_lshrrev_b32 v25, 5, v1
    v_bfe_u32 v26, v1, 1, 3
    v_xor_b32 v25, v25, v26
    v_lshlrev_b32 v25, 4, v25
    v_lshl_add_u32 v25, v24, 7, v25
    s_lshl_b32 s60, s30, 2
    s_add_u32 s60, s60, 12288
    v_add_u32 v25, s60, v25
    v_xor_b32 v8, 0, v25
    v_add_u32 v9, 0x10000, v8
    v_add_u32 v10, 0x20000, v8
    v_xor_b32 v11, 32, v25
    v_add_u32 v12, 0x10000, v11
    v_add_u32 v13, 0x20000, v11
    v_xor_b32 v14, 64, v25
    v_add_u32 v15, 0x10000, v14
    v_add_u32 v16, 0x20000, v14
    v_xor_b32 v17, 96, v25
    v_add_u32 v18, 0x10000, v17
    v_add_u32 v19, 0x20000, v17
    v_lshrrev_b32 v2, 5, v1
    v_lshlrev_b32 v20, 8, v2
    v_bfe_u32 v2, v1, 2, 2
    v_lshl_add_u32 v20, v2, 6, v20
    v_bfe_u32 v2, v1, 4, 1
    v_lshl_add_u32 v20, v2, 5, v20
    v_and_b32 v2, 3, v1
    v_lshl_add_u32 v20, v2, 3, v20
    v_and_b32 v2, 32, v1
    v_lshl_add_u32 v20, v2, 3, v20
    v_add_u32 v21, 0x10000, v20
    v_add_u32 v22, 0x20000, v20
    s_lshl_b32 s4, s18, 3
    s_and_b32 s5, s19, 1
    s_lshl_b32 s5, s5, 2
    s_add_u32 s4, s4, s5
    s_add_u32 s4, s4, s16
    s_lshr_b32 s5, s19, 1
    s_lshl_b32 s68, s5, 9
    s_mul_i32 s69, s18, 24576
    s_add_u32 s68, s68, s69
    s_add_u32 s68, s68, 45991936
    s_lshl_b32 s32, s5, 11
    s_mul_i32 s33, s4, 88064
    s_add_u32 s32, s32, s33
    s_add_u32 s32, s32, s77
    s_lshl_b32 s34, s5, 18
    s_lshl_b32 s35, s4, 11
    s_add_u32 s34, s34, s35
    s_add_u32 s34, s34, 8388608
    s_add_u32 s35, s34, 0x20000
    v_bfe_u32 v136, v1, 4, 1
    v_lshlrev_b32 v136, 17, v136
    v_lshrrev_b32 v134, 5, v1
    v_lshl_add_u32 v136, v134, 8, v136
    v_and_b32 v134, 15, v1
    v_lshl_add_u32 v136, v134, 4, v136
    v_and_b32 v137, 31, v1
    v_lshlrev_b32 v137, 4, v137
    v_lshrrev_b32 v134, 5, v1
    v_lshl_add_u32 v137, v134, 3, v137
    v_add_u32 v137, 145408, v137
    s_lshl_b32 s7, s4, 12
    s_add_u32 s7, s7, 18874368
    s_mov_b32 s6, 0x05040100
    v_mov_b32 v119, 0
    v_mov_b32 v123, 0
    v_mov_b32 v127, 0
    v_mov_b32 v148, 0x3f803f80
    v_mov_b32 v149, 0x3f803f80
    v_mov_b32 v150, 0x3f803f80
    v_mov_b32 v151, 0x3f803f80
    s_barrier
    ds_read_b128 v[104:107], v8 offset:0
    ds_read_b64_tr_b16 v[80:81], v20 offset:1024
    ds_read_b64_tr_b16 v[82:83], v20 offset:1280
    ds_read_b64_tr_b16 v[84:85], v20 offset:2048
    ds_read_b64_tr_b16 v[86:87], v20 offset:2304
    ds_read_b64_tr_b16 v[88:89], v20 offset:0
    ds_read_b64_tr_b16 v[90:91], v20 offset:256
    ds_read_b128 v[108:111], v11 offset:0
    ds_read_b64_tr_b16 v[92:93], v20 offset:4096
    ds_read_b64_tr_b16 v[94:95], v20 offset:4352
    ds_read_b64_tr_b16 v[96:97], v20 offset:5120
    ds_read_b64_tr_b16 v[98:99], v20 offset:5376
    s_waitcnt lgkmcnt(9)
    v_mfma_f32_32x32x16_bf16 v[48:63], v[80:83], v[104:107], 0
    ds_read_b64_tr_b16 v[100:101], v20 offset:3072
    ds_read_b64_tr_b16 v[102:103], v20 offset:3328
    ds_read_b128 v[112:115], v14 offset:0
    s_waitcnt lgkmcnt(10)
    v_mfma_f32_32x32x16_bf16 v[64:79], v[104:107], v[84:87], 0
    ds_read_b64_tr_b16 v[80:81], v20 offset:7168
    ds_read_b64_tr_b16 v[82:83], v20 offset:7424
    s_waitcnt lgkmcnt(10)
    v_mfma_f32_32x32x16_bf16 v[32:47], v[88:91], v[104:107], 0
    ds_read_b64_tr_b16 v[84:85], v20 offset:8192
    ds_read_b64_tr_b16 v[86:87], v20 offset:8448
    s_waitcnt lgkmcnt(9)
    v_mfma_f32_32x32x16_bf16 v[48:63], v[92:95], v[108:111], v[48:63]
    ds_read_b64_tr_b16 v[88:89], v20 offset:6144
    ds_read_b64_tr_b16 v[90:91], v20 offset:6400
    ds_read_b128 v[104:107], v17 offset:0
    s_waitcnt lgkmcnt(10)
    v_mfma_f32_32x32x16_bf16 v[64:79], v[108:111], v[96:99], v[64:79]
    ds_read_b64_tr_b16 v[92:93], v20 offset:10240
    ds_read_b64_tr_b16 v[94:95], v20 offset:10496
    s_waitcnt lgkmcnt(10)
    v_mfma_f32_32x32x16_bf16 v[32:47], v[100:103], v[108:111], v[32:47]
    ds_read_b64_tr_b16 v[96:97], v20 offset:11264
    ds_read_b64_tr_b16 v[98:99], v20 offset:11520
    s_waitcnt lgkmcnt(9)
    v_mfma_f32_32x32x16_bf16 v[48:63], v[80:83], v[112:115], v[48:63]
    ds_read_b64_tr_b16 v[100:101], v20 offset:9216
    ds_read_b64_tr_b16 v[102:103], v20 offset:9472
    s_barrier
    ds_read_b128 v[108:111], v8 offset:28672
    s_waitcnt lgkmcnt(10)
    v_mfma_f32_32x32x16_bf16 v[64:79], v[112:115], v[84:87], v[64:79]
    ds_read_b64_tr_b16 v[80:81], v20 offset:29696
    ds_read_b64_tr_b16 v[82:83], v20 offset:29952
    s_waitcnt lgkmcnt(10)
    v_mfma_f32_32x32x16_bf16 v[32:47], v[88:91], v[112:115], v[32:47]
    ds_read_b64_tr_b16 v[84:85], v20 offset:30720
    ds_read_b64_tr_b16 v[86:87], v20 offset:30976
    s_waitcnt lgkmcnt(9)
    v_mfma_f32_32x32x16_bf16 v[48:63], v[92:95], v[104:107], v[48:63]
    ds_read_b64_tr_b16 v[88:89], v20 offset:28672
    ds_read_b64_tr_b16 v[90:91], v20 offset:28928
    ds_read_b128 v[112:115], v11 offset:28672
    s_waitcnt lgkmcnt(10)
    v_mfma_f32_32x32x16_bf16 v[64:79], v[104:107], v[96:99], v[64:79]
    ds_read_b64_tr_b16 v[92:93], v20 offset:32768
    ds_read_b64_tr_b16 v[94:95], v20 offset:33024
    s_waitcnt lgkmcnt(10)
    v_mfma_f32_32x32x16_bf16 v[32:47], v[100:103], v[104:107], v[32:47]
    ds_read_b64_tr_b16 v[96:97], v20 offset:33792
    ds_read_b64_tr_b16 v[98:99], v20 offset:34048
    s_waitcnt lgkmcnt(9)
    v_mfma_f32_32x32x16_bf16 v[48:63], v[80:83], v[108:111], v[48:63]
    ds_read_b64_tr_b16 v[100:101], v20 offset:31744
    ds_read_b64_tr_b16 v[102:103], v20 offset:32000
    ds_read_b128 v[104:107], v14 offset:28672
    s_waitcnt lgkmcnt(10)
    v_mfma_f32_32x32x16_bf16 v[64:79], v[108:111], v[84:87], v[64:79]
    ds_read_b64_tr_b16 v[80:81], v20 offset:35840
    ds_read_b64_tr_b16 v[82:83], v20 offset:36096
    s_waitcnt lgkmcnt(10)
    v_mfma_f32_32x32x16_bf16 v[32:47], v[88:91], v[108:111], v[32:47]
    ds_read_b64_tr_b16 v[84:85], v20 offset:36864
    ds_read_b64_tr_b16 v[86:87], v20 offset:37120
    s_waitcnt lgkmcnt(9)
    v_mfma_f32_32x32x16_bf16 v[48:63], v[92:95], v[112:115], v[48:63]
    ds_read_b64_tr_b16 v[88:89], v20 offset:34816
    ds_read_b64_tr_b16 v[90:91], v20 offset:35072
    ds_read_b128 v[108:111], v17 offset:28672
    s_waitcnt lgkmcnt(10)
    v_mfma_f32_32x32x16_bf16 v[64:79], v[112:115], v[96:99], v[64:79]
    ds_read_b64_tr_b16 v[92:93], v20 offset:38912
    ds_read_b64_tr_b16 v[94:95], v20 offset:39168
    s_waitcnt lgkmcnt(10)
    v_mfma_f32_32x32x16_bf16 v[32:47], v[100:103], v[112:115], v[32:47]
    ds_read_b64_tr_b16 v[96:97], v20 offset:39936
    ds_read_b64_tr_b16 v[98:99], v20 offset:40192
    s_waitcnt lgkmcnt(9)
    v_mfma_f32_32x32x16_bf16 v[48:63], v[80:83], v[104:107], v[48:63]
    ds_read_b64_tr_b16 v[100:101], v20 offset:37888
    ds_read_b64_tr_b16 v[102:103], v20 offset:38144
    s_barrier
    ds_read_b128 v[112:115], v8 offset:57344
    s_waitcnt lgkmcnt(10)
    v_mfma_f32_32x32x16_bf16 v[64:79], v[104:107], v[84:87], v[64:79]
    ds_read_b64_tr_b16 v[80:81], v20 offset:58368
    ds_read_b64_tr_b16 v[82:83], v20 offset:58624
    s_waitcnt lgkmcnt(10)
    v_mfma_f32_32x32x16_bf16 v[32:47], v[88:91], v[104:107], v[32:47]
    ds_read_b64_tr_b16 v[84:85], v20 offset:59392
    ds_read_b64_tr_b16 v[86:87], v20 offset:59648
    s_waitcnt lgkmcnt(9)
    v_mfma_f32_32x32x16_bf16 v[48:63], v[92:95], v[108:111], v[48:63]
    ds_read_b64_tr_b16 v[88:89], v20 offset:57344
    ds_read_b64_tr_b16 v[90:91], v20 offset:57600
    ds_read_b128 v[104:107], v11 offset:57344
    s_waitcnt lgkmcnt(10)
    v_mfma_f32_32x32x16_bf16 v[64:79], v[108:111], v[96:99], v[64:79]
    ds_read_b64_tr_b16 v[92:93], v20 offset:61440
    ds_read_b64_tr_b16 v[94:95], v20 offset:61696
    s_waitcnt lgkmcnt(10)
    v_mfma_f32_32x32x16_bf16 v[32:47], v[100:103], v[108:111], v[32:47]
    ds_read_b64_tr_b16 v[96:97], v20 offset:62464
    ds_read_b64_tr_b16 v[98:99], v20 offset:62720
    s_waitcnt lgkmcnt(9)
    v_mfma_f32_32x32x16_bf16 v[48:63], v[80:83], v[112:115], v[48:63]
    ds_read_b64_tr_b16 v[100:101], v20 offset:60416
    ds_read_b64_tr_b16 v[102:103], v20 offset:60672
    ds_read_b128 v[108:111], v14 offset:57344
    s_waitcnt lgkmcnt(10)
    v_mfma_f32_32x32x16_bf16 v[64:79], v[112:115], v[84:87], v[64:79]
    ds_read_b64_tr_b16 v[80:81], v20 offset:64512
    ds_read_b64_tr_b16 v[82:83], v20 offset:64768
    s_waitcnt lgkmcnt(10)
    v_mfma_f32_32x32x16_bf16 v[32:47], v[88:91], v[112:115], v[32:47]
    ds_read_b64_tr_b16 v[84:85], v21 offset:0
    ds_read_b64_tr_b16 v[86:87], v21 offset:256
    s_waitcnt lgkmcnt(9)
    v_mfma_f32_32x32x16_bf16 v[48:63], v[92:95], v[104:107], v[48:63]
    ds_read_b64_tr_b16 v[88:89], v20 offset:63488
    ds_read_b64_tr_b16 v[90:91], v20 offset:63744
    ds_read_b128 v[112:115], v17 offset:57344
    s_waitcnt lgkmcnt(10)
    v_mfma_f32_32x32x16_bf16 v[64:79], v[104:107], v[96:99], v[64:79]
    ds_read_b64_tr_b16 v[92:93], v21 offset:2048
    ds_read_b64_tr_b16 v[94:95], v21 offset:2304
    s_waitcnt lgkmcnt(10)
    v_mfma_f32_32x32x16_bf16 v[32:47], v[100:103], v[104:107], v[32:47]
    ds_read_b64_tr_b16 v[96:97], v21 offset:3072
    ds_read_b64_tr_b16 v[98:99], v21 offset:3328
    s_waitcnt lgkmcnt(9)
    v_mfma_f32_32x32x16_bf16 v[48:63], v[80:83], v[108:111], v[48:63]
    ds_read_b64_tr_b16 v[100:101], v21 offset:1024
    ds_read_b64_tr_b16 v[102:103], v21 offset:1280
    s_waitcnt vmcnt(0)
    s_or_b32 s60, s16, s20
    s_cmp_lg_u32 s60, 0
    s_cbranch_scc1 L_tp_20
    s_waitcnt vmcnt(0)
    v_bfe_u32 v2, v201, 8, 16
    v_mov_b32 v200, 143360
    s_mov_b64 exec, 1
    ds_write_b32 v200, v2 offset:4
    s_mov_b64 exec, -1
    s_waitcnt lgkmcnt(0)
L_tp_20:
    s_barrier
    ds_read_b128 v[104:107], v9 offset:20480
    s_waitcnt lgkmcnt(10)
    v_mfma_f32_32x32x16_bf16 v[64:79], v[108:111], v[84:87], v[64:79]
    ds_read_b64_tr_b16 v[80:81], v21 offset:21504
    ds_read_b64_tr_b16 v[82:83], v21 offset:21760
    s_waitcnt lgkmcnt(10)
    v_mfma_f32_32x32x16_bf16 v[32:47], v[88:91], v[108:111], v[32:47]
    ds_read_b64_tr_b16 v[84:85], v21 offset:22528
    ds_read_b64_tr_b16 v[86:87], v21 offset:22784
    s_waitcnt lgkmcnt(9)
    v_mfma_f32_32x32x16_bf16 v[48:63], v[92:95], v[112:115], v[48:63]
    ds_read_b64_tr_b16 v[88:89], v21 offset:20480
    ds_read_b64_tr_b16 v[90:91], v21 offset:20736
    ds_read_b128 v[108:111], v12 offset:20480
    s_waitcnt lgkmcnt(10)
    v_mfma_f32_32x32x16_bf16 v[64:79], v[112:115], v[96:99], v[64:79]
    ds_read_b64_tr_b16 v[92:93], v21 offset:24576
    ds_read_b64_tr_b16 v[94:95], v21 offset:24832
    s_waitcnt lgkmcnt(10)
    v_mfma_f32_32x32x16_bf16 v[32:47], v[100:103], v[112:115], v[32:47]
    ds_read_b64_tr_b16 v[96:97], v21 offset:25600
    ds_read_b64_tr_b16 v[98:99], v21 offset:25856
    s_waitcnt lgkmcnt(9)
    v_mfma_f32_32x32x16_bf16 v[48:63], v[80:83], v[104:107], v[48:63]
    ds_read_b64_tr_b16 v[100:101], v21 offset:23552
    ds_read_b64_tr_b16 v[102:103], v21 offset:23808
    ds_read_b128 v[112:115], v15 offset:20480
    s_waitcnt lgkmcnt(10)
    v_mfma_f32_32x32x16_bf16 v[64:79], v[104:107], v[84:87], v[64:79]
    ds_read_b64_tr_b16 v[80:81], v21 offset:27648
    ds_read_b64_tr_b16 v[82:83], v21 offset:27904
    s_waitcnt lgkmcnt(10)
    v_mfma_f32_32x32x16_bf16 v[32:47], v[88:91], v[104:107], v[32:47]
    ds_read_b64_tr_b16 v[84:85], v21 offset:28672
    ds_read_b64_tr_b16 v[86:87], v21 offset:28928
    s_waitcnt lgkmcnt(9)
    v_mfma_f32_32x32x16_bf16 v[48:63], v[92:95], v[108:111], v[48:63]
    ds_read_b64_tr_b16 v[88:89], v21 offset:26624
    ds_read_b64_tr_b16 v[90:91], v21 offset:26880
    ds_read_b128 v[104:107], v18 offset:20480
    s_waitcnt lgkmcnt(10)
    v_mfma_f32_32x32x16_bf16 v[64:79], v[108:111], v[96:99], v[64:79]
    ds_read_b64_tr_b16 v[92:93], v21 offset:30720
    ds_read_b64_tr_b16 v[94:95], v21 offset:30976
    s_waitcnt lgkmcnt(10)
    v_mfma_f32_32x32x16_bf16 v[32:47], v[100:103], v[108:111], v[32:47]
    ds_read_b64_tr_b16 v[96:97], v21 offset:31744
    ds_read_b64_tr_b16 v[98:99], v21 offset:32000
    s_waitcnt lgkmcnt(9)
    v_mfma_f32_32x32x16_bf16 v[48:63], v[80:83], v[112:115], v[48:63]
    ds_read_b64_tr_b16 v[100:101], v21 offset:29696
    ds_read_b64_tr_b16 v[102:103], v21 offset:29952
    s_barrier
    v_mov_b32 v2, 143360
    ds_read_b64 v[30:31], v2
    ds_read_b128 v[108:111], v9 offset:49152
    s_waitcnt lgkmcnt(10)
    v_mfma_f32_32x32x16_bf16 v[64:79], v[112:115], v[84:87], v[64:79]
    ds_read_b64_tr_b16 v[80:81], v21 offset:50176
    ds_read_b64_tr_b16 v[82:83], v21 offset:50432
    s_waitcnt lgkmcnt(10)
    v_mfma_f32_32x32x16_bf16 v[32:47], v[88:91], v[112:115], v[32:47]
    ds_read_b64_tr_b16 v[84:85], v21 offset:51200
    ds_read_b64_tr_b16 v[86:87], v21 offset:51456
    s_waitcnt lgkmcnt(9)
    v_mfma_f32_32x32x16_bf16 v[48:63], v[92:95], v[104:107], v[48:63]
    ds_read_b64_tr_b16 v[88:89], v21 offset:49152
    ds_read_b64_tr_b16 v[90:91], v21 offset:49408
    ds_read_b128 v[112:115], v12 offset:49152
    s_waitcnt lgkmcnt(10)
    v_mfma_f32_32x32x16_bf16 v[64:79], v[104:107], v[96:99], v[64:79]
    ds_read_b64_tr_b16 v[92:93], v21 offset:53248
    ds_read_b64_tr_b16 v[94:95], v21 offset:53504
    s_waitcnt lgkmcnt(10)
    v_mfma_f32_32x32x16_bf16 v[32:47], v[100:103], v[104:107], v[32:47]
    ds_read_b64_tr_b16 v[96:97], v21 offset:54272
    ds_read_b64_tr_b16 v[98:99], v21 offset:54528
    s_waitcnt lgkmcnt(9)
    v_mfma_f32_32x32x16_bf16 v[48:63], v[80:83], v[108:111], v[48:63]
    ds_read_b64_tr_b16 v[100:101], v21 offset:52224
    ds_read_b64_tr_b16 v[102:103], v21 offset:52480
    ds_read_b128 v[104:107], v15 offset:49152
    s_waitcnt lgkmcnt(10)
    v_mfma_f32_32x32x16_bf16 v[64:79], v[108:111], v[84:87], v[64:79]
    ds_read_b64_tr_b16 v[80:81], v21 offset:56320
    ds_read_b64_tr_b16 v[82:83], v21 offset:56576
    s_waitcnt lgkmcnt(10)
    v_mfma_f32_32x32x16_bf16 v[32:47], v[88:91], v[108:111], v[32:47]
    ds_read_b64_tr_b16 v[84:85], v21 offset:57344
    ds_read_b64_tr_b16 v[86:87], v21 offset:57600
    s_waitcnt lgkmcnt(9)
    v_mfma_f32_32x32x16_bf16 v[48:63], v[92:95], v[112:115], v[48:63]
    ds_read_b64_tr_b16 v[88:89], v21 offset:55296
    ds_read_b64_tr_b16 v[90:91], v21 offset:55552
    ds_read_b128 v[108:111], v18 offset:49152
    s_waitcnt lgkmcnt(10)
    v_mfma_f32_32x32x16_bf16 v[64:79], v[112:115], v[96:99], v[64:79]
    ds_read_b64_tr_b16 v[92:93], v21 offset:59392
    ds_read_b64_tr_b16 v[94:95], v21 offset:59648
    s_waitcnt lgkmcnt(10)
    v_mfma_f32_32x32x16_bf16 v[32:47], v[100:103], v[112:115], v[32:47]
    ds_read_b64_tr_b16 v[96:97], v21 offset:60416
    ds_read_b64_tr_b16 v[98:99], v21 offset:60672
    s_waitcnt lgkmcnt(9)
    v_mfma_f32_32x32x16_bf16 v[48:63], v[80:83], v[104:107], v[48:63]
    ds_read_b64_tr_b16 v[100:101], v21 offset:58368
    ds_read_b64_tr_b16 v[102:103], v21 offset:58624
    s_barrier
    v_readfirstlane_b32 s60, v30
    s_andn2_b32 s60, s60, s20
    s_mov_b32 s20, 3
    s_cmp_eq_u32 s60, 0
    s_cbranch_scc1 L_valid_21
    v_readfirstlane_b32 s61, v31
    s_waitcnt vmcnt(0) lgkmcnt(0)
    s_nop 15
    s_barrier
    s_mov_b32 s19, s61
    s_cmp_eq_u32 s60, 1
    s_cbranch_scc1 L_roles_2
    s_and_b32 s18, s2, 7
    s_lshr_b32 s19, s2, 3
    s_mov_b32 s22, 1
    s_branch L_roles_2
L_valid_21:
    ds_read_b128 v[112:115], v8 offset:0
    s_waitcnt lgkmcnt(10)
    v_mfma_f32_32x32x16_bf16 v[64:79], v[104:107], v[84:87], v[64:79]
    ds_read_b64_tr_b16 v[80:81], v20 offset:1024
    ds_read_b64_tr_b16 v[82:83], v20 offset:1280
    s_waitcnt lgkmcnt(10)
    v_mfma_f32_32x32x16_bf16 v[32:47], v[88:91], v[104:107], v[32:47]
    ds_read_b64_tr_b16 v[84:85], v20 offset:2048
    ds_read_b64_tr_b16 v[86:87], v20 offset:2304
    s_waitcnt lgkmcnt(9)
    v_mfma_f32_32x32x16_bf16 v[48:63], v[92:95], v[108:111], v[48:63]
    ds_read_b128 v[104:107], v11 offset:0
    ds_read_b64_tr_b16 v[88:89], v20 offset:4096
    ds_read_b64_tr_b16 v[90:91], v20 offset:4352
    s_waitcnt lgkmcnt(10)
    v_mfma_f32_32x32x16_bf16 v[64:79], v[108:111], v[96:99], v[64:79]
    ds_read_b64_tr_b16 v[92:93], v20 offset:5120
    ds_read_b64_tr_b16 v[94:95], v20 offset:5376
    s_waitcnt lgkmcnt(10)
    v_mfma_f32_32x32x16_bf16 v[32:47], v[100:103], v[108:111], v[32:47]
    ds_read_b128 v[108:111], v14 offset:0
    s_waitcnt lgkmcnt(8)
    v_mfma_f32_32x32x16_bf16 v[48:63], v[80:83], v[112:115], v[48:63]
    ds_read_b64_tr_b16 v[96:97], v20 offset:7168
    ds_read_b64_tr_b16 v[98:99], v20 offset:7424
    ds_read_b64_tr_b16 v[100:101], v20 offset:8192
    ds_read_b64_tr_b16 v[102:103], v20 offset:8448
    s_waitcnt lgkmcnt(10)
    v_mfma_f32_32x32x16_bf16 v[64:79], v[112:115], v[84:87], v[64:79]
    ds_read_b128 v[112:115], v17 offset:0
    s_waitcnt lgkmcnt(8)
    v_mfma_f32_32x32x16_bf16 v[48:63], v[88:91], v[104:107], v[48:63]
    ds_read_b64_tr_b16 v[80:81], v20 offset:10240
    ds_read_b64_tr_b16 v[82:83], v20 offset:10496
    ds_read_b64_tr_b16 v[84:85], v20 offset:11264
    ds_read_b64_tr_b16 v[86:87], v20 offset:11520
    s_waitcnt lgkmcnt(10)
    v_mfma_f32_32x32x16_bf16 v[64:79], v[104:107], v[92:95], v[64:79]
    s_barrier
    buffer_load_dwordx4 v[152:155], v3, s[8:11], s7 offen offset:0 sc1
    buffer_load_dwordx4 v[156:159], v3, s[8:11], s7 offen offset:1024 sc1
    buffer_load_dwordx4 v[160:163], v3, s[8:11], s7 offen offset:2048 sc1
    buffer_load_dwordx4 v[164:167], v3, s[8:11], s7 offen offset:3072 sc1
    ds_read_b128 v[104:107], v8 offset:28672
    s_waitcnt lgkmcnt(8)
    v_mfma_f32_32x32x16_bf16 v[48:63], v[96:99], v[108:111], v[48:63]
    ds_read_b64_tr_b16 v[88:89], v20 offset:29696
    ds_read_b64_tr_b16 v[90:91], v20 offset:29952
    ds_read_b64_tr_b16 v[92:93], v20 offset:30720
    ds_read_b64_tr_b16 v[94:95], v20 offset:30976
    s_waitcnt lgkmcnt(10)
    v_mfma_f32_32x32x16_bf16 v[64:79], v[108:111], v[100:103], v[64:79]
    ds_read_b128 v[108:111], v11 offset:28672
    s_waitcnt lgkmcnt(8)
    v_mfma_f32_32x32x16_bf16 v[48:63], v[80:83], v[112:115], v[48:63]
    ds_read_b64_tr_b16 v[96:97], v20 offset:32768
    ds_read_b64_tr_b16 v[98:99], v20 offset:33024
    ds_read_b64_tr_b16 v[100:101], v20 offset:33792
    ds_read_b64_tr_b16 v[102:103], v20 offset:34048
    s_waitcnt lgkmcnt(10)
    v_mfma_f32_32x32x16_bf16 v[64:79], v[112:115], v[84:87], v[64:79]
    ds_read_b128 v[112:115], v14 offset:28672
    s_waitcnt lgkmcnt(8)
    v_mfma_f32_32x32x16_bf16 v[48:63], v[88:91], v[104:107], v[48:63]
    ds_read_b64_tr_b16 v[80:81], v20 offset:35840
    ds_read_b64_tr_b16 v[82:83], v20 offset:36096
    ds_read_b64_tr_b16 v[84:85], v20 offset:36864
    ds_read_b64_tr_b16 v[86:87], v20 offset:37120
    s_waitcnt lgkmcnt(10)
    v_mfma_f32_32x32x16_bf16 v[64:79], v[104:107], v[92:95], v[64:79]
    ds_read_b128 v[104:107], v17 offset:28672
    s_waitcnt lgkmcnt(8)
    v_mfma_f32_32x32x16_bf16 v[48:63], v[96:99], v[108:111], v[48:63]
    ds_read_b64_tr_b16 v[88:89], v20 offset:38912
    ds_read_b64_tr_b16 v[90:91], v20 offset:39168
    ds_read_b64_tr_b16 v[92:93], v20 offset:39936
    ds_read_b64_tr_b16 v[94:95], v20 offset:40192
    s_waitcnt lgkmcnt(10)
    v_mfma_f32_32x32x16_bf16 v[64:79], v[108:111], v[100:103], v[64:79]
    s_barrier
    ds_read_b128 v[108:111], v8 offset:57344
    s_waitcnt lgkmcnt(8)
    v_mfma_f32_32x32x16_bf16 v[48:63], v[80:83], v[112:115], v[48:63]
    ds_read_b64_tr_b16 v[96:97], v20 offset:58368
    ds_read_b64_tr_b16 v[98:99], v20 offset:58624
    ds_read_b64_tr_b16 v[100:101], v20 offset:59392
    ds_read_b64_tr_b16 v[102:103], v20 offset:59648
    s_waitcnt vmcnt(0)
    v_add_f32 v152, v152, v160
    v_add_f32 v153, v153, v161
    v_add_f32 v154, v154, v162
    v_add_f32 v155, v155, v163
    s_waitcnt lgkmcnt(10)
    v_mfma_f32_32x32x16_bf16 v[64:79], v[112:115], v[84:87], v[64:79]
    ds_read_b128 v[112:115], v11 offset:57344
    v_add_f32 v156, v156, v164
    v_add_f32 v157, v157, v165
    v_add_f32 v158, v158, v166
    v_add_f32 v159, v159, v167
    v_add_f32 v152, v152, v156
    s_waitcnt lgkmcnt(8)
    v_mfma_f32_32x32x16_bf16 v[48:63], v[88:91], v[104:107], v[48:63]
    ds_read_b64_tr_b16 v[80:81], v20 offset:61440
    ds_read_b64_tr_b16 v[82:83], v20 offset:61696
    ds_read_b64_tr_b16 v[84:85], v20 offset:62464
    ds_read_b64_tr_b16 v[86:87], v20 offset:62720
    v_add_f32 v153, v153, v157
    v_add_f32 v154, v154, v158
    v_add_f32 v155, v155, v159
    v_add_f32 v152, v152, v154
    v_add_f32 v153, v153, v155
    s_waitcnt lgkmcnt(10)
    v_mfma_f32_32x32x16_bf16 v[64:79], v[104:107], v[92:95], v[64:79]
    ds_read_b128 v[104:107], v14 offset:57344
    v_add_f32 v152, v152, v153
    v_mov_b32 v129, v152
    s_nop 1
    v_permlane32_swap_b32 v152, v129
    s_nop 1
    s_waitcnt lgkmcnt(8)
    v_mfma_f32_32x32x16_bf16 v[48:63], v[96:99], v[108:111], v[48:63]
    ds_read_b64_tr_b16 v[88:89], v20 offset:64512
    ds_read_b64_tr_b16 v[90:91], v20 offset:64768
    ds_read_b64_tr_b16 v[92:93], v21 offset:0
    ds_read_b64_tr_b16 v[94:95], v21 offset:256
    v_mul_f32 v128, 0xbb000000, v152
    v_mul_f32 v129, 0x3b000000, v129
    v_fma_f32 v129, -v128, v128, v129
    v_max_f32 v129, 0, v129
    v_add_f32 v129, 0x3727c5ac, v129
    s_waitcnt lgkmcnt(10)
    v_mfma_f32_32x32x16_bf16 v[64:79], v[108:111], v[100:103], v[64:79]
    ds_read_b128 v[108:111], v17 offset:57344
    v_rsq_f32 v130, v129
    s_nop 0
    v_cvt_pk_bf16_f32 v140, v128, v128
    v_and_b32 v129, 0xffff0000, v140
    v_sub_f32 v129, v128, v129
    s_waitcnt lgkmcnt(8)
    v_mfma_f32_32x32x16_bf16 v[48:63], v[80:83], v[112:115], v[48:63]
    ds_read_b64_tr_b16 v[96:97], v21 offset:2048
    ds_read_b64_tr_b16 v[98:99], v21 offset:2304
    ds_read_b64_tr_b16 v[100:101], v21 offset:3072
    ds_read_b64_tr_b16 v[102:103], v21 offset:3328
    v_mov_b32 v141, v140
    v_cvt_pk_bf16_f32 v142, v129, v129
    v_mov_b32 v143, 0
    v_cmp_gt_u32 vcc, 32, v1
    v_mov_b32 v131, v130
    s_waitcnt lgkmcnt(10)
    v_mfma_f32_32x32x16_bf16 v[64:79], v[112:115], v[84:87], v[64:79]
    ds_read_b128 v[112:115], v8 offset:0
    v_mul_f32 v132, 0x3eb8aa3b, v130
    v_cndmask_b32 v134, 0, v130, vcc
    v_cvt_pk_bf16_f32 v144, v134, v134
    v_and_b32 v129, 0xffff0000, v144
    v_sub_f32 v129, v134, v129
    s_waitcnt lgkmcnt(8)
    v_mfma_f32_32x32x16_bf16 v[48:63], v[88:91], v[104:107], v[48:63]
    ds_read_b64_tr_b16 v[80:81], v20 offset:0
    ds_read_b64_tr_b16 v[82:83], v20 offset:256
    v_cvt_pk_bf16_f32 v144, v134, v129
    v_mov_b32 v145, 0
    v_mov_b32 v146, 0
    v_mov_b32 v147, 0
    v_mov_b32 v133, v132
    s_waitcnt lgkmcnt(8)
    v_mfma_f32_32x32x16_bf16 v[64:79], v[104:107], v[92:95], v[64:79]
    ds_read_b128 v[104:107], v11 offset:0
    ds_read_b64_tr_b16 v[84:85], v20 offset:3072
    ds_read_b64_tr_b16 v[86:87], v20 offset:3328
    s_nop 0
    v_mfma_f32_32x32x16_bf16 v[152:167], v[144:147], v[148:151], 0
    s_waitcnt lgkmcnt(8)
    v_mfma_f32_32x32x16_bf16 v[48:63], v[96:99], v[108:111], v[48:63]
    s_waitcnt lgkmcnt(6)
    v_mfma_f32_32x32x16_bf16 v[64:79], v[108:111], v[100:103], v[64:79]
    ds_read_b128 v[108:111], v14 offset:0
    ds_read_b64_tr_b16 v[88:89], v20 offset:6144
    ds_read_b64_tr_b16 v[90:91], v20 offset:6400
    s_barrier
    ds_read_b64 v[116:117], v137 offset:0
    ds_read_b64 v[120:121], v137 offset:512
    ds_read_b64 v[124:125], v137 offset:1024
    s_waitcnt lgkmcnt(0)
    v_perm_b32 v118, v117, v116, s6
    v_perm_b32 v122, v121, v120, s6
    v_perm_b32 v126, v125, v124, s6
    s_nop 1
    v_mfma_f32_32x32x16_bf16 v[48:63], v[120:123], v[140:143], v[48:63]
    v_mfma_f32_32x32x16_bf16 v[64:79], v[140:143], v[124:127], v[64:79]
    v_mfma_f32_32x32x16_bf16 v[32:47], v[116:119], v[140:143], v[32:47]
    s_cmp_lg_u32 s16, 3
    s_cbranch_scc1 L_w0_22
    buffer_store_dwordx2 v[116:117], v137, s[8:11], s68 offen sc1
    s_add_u32 s68, s68, 8192
    buffer_store_dwordx2 v[120:121], v137, s[8:11], s68 offen sc1
    s_add_u32 s68, s68, 8192
    buffer_store_dwordx2 v[124:125], v137, s[8:11], s68 offen sc1
    s_add_u32 s68, s68, 8192
L_w0_22:
    s_waitcnt lgkmcnt(6)
    v_mfma_f32_32x32x16_bf16 v[32:47], v[80:83], v[112:115], v[32:47]
    ds_read_b128 v[112:115], v17 offset:0
    ds_read_b64_tr_b16 v[92:93], v20 offset:9216
    ds_read_b64_tr_b16 v[94:95], v20 offset:9472
    s_waitcnt lgkmcnt(6)
    v_mfma_f32_32x32x16_bf16 v[32:47], v[84:87], v[104:107], v[32:47]
    ds_read_b128 v[104:107], v8 offset:28672
    ds_read_b64_tr_b16 v[96:97], v20 offset:28672
    ds_read_b64_tr_b16 v[98:99], v20 offset:28928
    s_waitcnt lgkmcnt(6)
    v_mfma_f32_32x32x16_bf16 v[32:47], v[88:91], v[108:111], v[32:47]
    ds_read_b128 v[108:111], v11 offset:28672
    ds_read_b64_tr_b16 v[100:101], v20 offset:31744
    ds_read_b64_tr_b16 v[102:103], v20 offset:32000
    v_mul_f32 v48, v48, v130
    v_mul_f32 v49, v49, v130
    v_mul_f32 v50, v50, v130
    v_mul_f32 v51, v51, v130
    v_mul_f32 v52, v52, v130
    s_waitcnt lgkmcnt(6)
    v_mfma_f32_32x32x16_bf16 v[32:47], v[92:95], v[112:115], v[32:47]
    ds_read_b128 v[112:115], v14 offset:28672
    ds_read_b64_tr_b16 v[80:81], v20 offset:34816
    ds_read_b64_tr_b16 v[82:83], v20 offset:35072
    v_mul_f32 v53, v53, v130
    v_mul_f32 v54, v54, v130
    v_mul_f32 v55, v55, v130
    v_mul_f32 v56, v56, v130
    v_mul_f32 v57, v57, v130
    s_waitcnt lgkmcnt(6)
    v_mfma_f32_32x32x16_bf16 v[32:47], v[96:99], v[104:107], v[32:47]
    ds_read_b128 v[104:107], v17 offset:28672
    ds_read_b64_tr_b16 v[84:85], v20 offset:37888
    ds_read_b64_tr_b16 v[86:87], v20 offset:38144
    v_mul_f32 v58, v58, v130
    v_mul_f32 v59, v59, v130
    v_mul_f32 v60, v60, v130
    v_mul_f32 v61, v61, v130
    v_mul_f32 v62, v62, v130
    s_waitcnt lgkmcnt(6)
    v_mfma_f32_32x32x16_bf16 v[32:47], v[100:103], v[108:111], v[32:47]
    ds_read_b128 v[108:111], v8 offset:57344
    ds_read_b64_tr_b16 v[88:89], v20 offset:57344
    ds_read_b64_tr_b16 v[90:91], v20 offset:57600
    v_mul_f32 v63, v63, v130
    v_cvt_pk_bf16_f32 v48, v48, v49
    v_cvt_pk_bf16_f32 v49, v50, v51
    v_cvt_pk_bf16_f32 v50, v52, v53
    v_cvt_pk_bf16_f32 v51, v54, v55
    s_waitcnt lgkmcnt(6)
    v_mfma_f32_32x32x16_bf16 v[32:47], v[80:83], v[112:115], v[32:47]
    ds_read_b128 v[112:115], v11 offset:57344
    ds_read_b64_tr_b16 v[92:93], v20 offset:60416
    ds_read_b64_tr_b16 v[94:95], v20 offset:60672
    v_cvt_pk_bf16_f32 v52, v56, v57
    v_cvt_pk_bf16_f32 v53, v58, v59
    v_cvt_pk_bf16_f32 v54, v60, v61
    v_cvt_pk_bf16_f32 v55, v62, v63
    buffer_store_dwordx4 v[48:51], v3, s[8:11], s34 offen sc1
    s_waitcnt lgkmcnt(6)
    v_mfma_f32_32x32x16_bf16 v[32:47], v[84:87], v[104:107], v[32:47]
    ds_read_b128 v[104:107], v14 offset:57344
    ds_read_b64_tr_b16 v[96:97], v20 offset:63488
    ds_read_b64_tr_b16 v[98:99], v20 offset:63744
    buffer_store_dwordx4 v[52:55], v3, s[8:11], s35 offen sc1
    v_mul_f32 v64, v64, v152
    v_mul_f32 v65, v65, v153
    v_mul_f32 v66, v66, v154
    v_mul_f32 v67, v67, v155
    s_waitcnt lgkmcnt(6)
    v_mfma_f32_32x32x16_bf16 v[32:47], v[88:91], v[108:111], v[32:47]
    ds_read_b128 v[108:111], v17 offset:57344
    ds_read_b64_tr_b16 v[100:101], v21 offset:1024
    ds_read_b64_tr_b16 v[102:103], v21 offset:1280
    v_mul_f32 v68, v68, v156
    v_mul_f32 v69, v69, v157
    v_mul_f32 v70, v70, v158
    v_mul_f32 v71, v71, v159
    v_mul_f32 v72, v72, v160
    s_waitcnt lgkmcnt(6)
    v_mfma_f32_32x32x16_bf16 v[32:47], v[92:95], v[112:115], v[32:47]
    v_mul_f32 v73, v73, v161
    v_mul_f32 v74, v74, v162
    v_mul_f32 v75, v75, v163
    v_mul_f32 v76, v76, v164
    v_mul_f32 v77, v77, v165
    s_waitcnt lgkmcnt(3)
    v_mfma_f32_32x32x16_bf16 v[32:47], v[96:99], v[104:107], v[32:47]
    v_mul_f32 v78, v78, v166
    v_mul_f32 v79, v79, v167
    v_cvt_pk_bf16_f32 v64, v64, v65
    v_cvt_pk_bf16_f32 v65, v66, v67
    v_cvt_pk_bf16_f32 v66, v68, v69
    s_waitcnt lgkmcnt(0)
    v_mfma_f32_32x32x16_bf16 v[32:47], v[100:103], v[108:111], v[32:47]
    v_cvt_pk_bf16_f32 v67, v70, v71
    v_cvt_pk_bf16_f32 v68, v72, v73
    v_cvt_pk_bf16_f32 v69, v74, v75
    v_cvt_pk_bf16_f32 v70, v76, v77
    v_cvt_pk_bf16_f32 v71, v78, v79
    buffer_store_dwordx4 v[64:67], v136, s[8:11], s34 offen offset:1024 sc1
    buffer_store_dwordx4 v[68:71], v136, s[8:11], s34 offen offset:1536 sc1
    s_nop 11
    v_pk_mul_f32 v[32:33], v[32:33], v[132:133]
    v_pk_mul_f32 v[34:35], v[34:35], v[132:133]
    v_pk_mul_f32 v[36:37], v[36:37], v[132:133]
    v_pk_mul_f32 v[38:39], v[38:39], v[132:133]
    v_pk_mul_f32 v[40:41], v[40:41], v[132:133]
    v_pk_mul_f32 v[42:43], v[42:43], v[132:133]
    v_pk_mul_f32 v[44:45], v[44:45], v[132:133]
    v_pk_mul_f32 v[46:47], v[46:47], v[132:133]
    v_cvt_pk_bf16_f32 v32, v32, v33
    v_cvt_pk_bf16_f32 v33, v34, v35
    v_cvt_pk_bf16_f32 v34, v36, v37
    v_cvt_pk_bf16_f32 v35, v38, v39
    v_cvt_pk_bf16_f32 v36, v40, v41
    v_cvt_pk_bf16_f32 v37, v42, v43
    v_cvt_pk_bf16_f32 v38, v44, v45
    v_cvt_pk_bf16_f32 v39, v46, v47
    buffer_store_dwordx4 v[32:35], v3, s[8:11], s32 offen sc1
    buffer_store_dwordx4 v[36:39], v3, s[8:11], s32 offen offset:1024 sc1
    s_add_u32 s61, s25, 1
    v_mov_b32 v2, s61
    s_mov_b64 exec, 1
    s_waitcnt vmcnt(0)
    s_cmp_lg_u32 s22, 0
    s_cbranch_scc1 L_sts_23
    buffer_store_dword v2, v253, s[8:11], s21 offen
L_std_24:
    s_mov_b64 exec, -1
L_se_4:
L_layer_25:
    s_cmp_ge_u32 s16, 4
    s_cbranch_scc1 L_gsig_26
    v_mov_b32 v2, 1
    s_mov_b64 exec, 1
    ds_add_rtn_u32 v2, v0, v2
    s_add_u32 s78, s78, 4
    s_sub_u32 s61, s78, 1
    s_waitcnt lgkmcnt(0)
    v_readfirstlane_b32 s62, v2
    s_mov_b64 exec, -1
    s_cmp_lg_u32 s61, s62
    s_cbranch_scc1 L_arr_27
    s_lshl_b32 s61, s24, 11
    s_lshr_b32 s62, s19, 1
    s_lshl_b32 s62, s62, 7
    s_add_u32 s61, s61, s62
    s_lshl_b32 s62, s18, 1
    s_and_b32 s63, s19, 1
    s_add_u32 s62, s62, s63
    s_lshl_b32 s62, s62, 2
    s_add_u32 s61, s61, s62
    s_add_u32 s61, s61, 54599680
    v_mov_b32 v2, 1
    s_mov_b64 exec, 1
    buffer_store_dword v2, v7, s[8:11], s61 offen sc1
    s_mov_b64 exec, -1
L_arr_27:
L_gsig_26:
    s_setprio 0
    s_and_b32 s32, s16, 1
    s_lshr_b32 s33, s16, 1
    s_lshl_b32 s36, s18, 3
    s_lshl_b32 s37, s32, 2
    s_add_u32 s36, s36, s37
    s_add_u32 s34, s36, s33
    s_lshl_b32 s35, s19, 17
    s_add_u32 s35, s35, s23
    s_add_u32 s35, s35, 8388608
    s_lshl_b32 s38, s33, 12
    s_lshl_b32 s46, s18, 14
    s_add_u32 s46, s46, s38
    s_lshl_b32 s53, s24, 11
    s_lshr_b32 s47, s19, 1
    s_lshl_b32 s47, s47, 7
    s_add_u32 s53, s53, s47
    s_add_u32 s53, s53, 54599680
    s_lshl_b32 s39, s19, 10
    s_add_u32 s39, s39, s77
    s_mul_i32 s36, s36, 88064
    s_add_u32 s39, s39, s36
    s_add_u32 s37, s33, 0
    s_and_b32 s37, s37, 3
    s_mul_i32 s37, s37, 88064
    s_add_u32 s40, s39, s37
    s_add_u32 s37, s33, 1
    s_and_b32 s37, s37, 3
    s_mul_i32 s37, s37, 88064
    s_add_u32 s41, s39, s37
    s_add_u32 s37, s33, 2
    s_and_b32 s37, s37, 3
    s_mul_i32 s37, s37, 88064
    s_add_u32 s42, s39, s37
    s_add_u32 s37, s33, 3
    s_and_b32 s37, s37, 3
    s_mul_i32 s37, s37, 88064
    s_add_u32 s43, s39, s37
    s_cmp_lg_u32 s16, 7
    s_cbranch_scc1 L_w0_28
    s_and_b32 s63, s19, 30
    s_lshl_b32 s63, 3, s63
    s_add_u32 s62, s25, 1
    s_mov_b32 exec_lo, s63
    s_mov_b32 exec_hi, 0
    s_mov_b32 s60, 0
    buffer_load_dwordx4 v[244:247], v254, s[8:11], s31 offen sc1
L_poll_29:
    buffer_load_dwordx4 v[248:251], v254, s[8:11], s31 offen sc1
    s_waitcnt vmcnt(1)
    v_min3_u32 v244, v244, v245, v246
    v_min_u32 v244, v244, v247
    v_cmp_gt_u32 vcc, s62, v244
    s_add_u32 s60, s60, 1
    s_cmp_gt_u32 s60, 0x4000
    s_cbranch_vccz L_polld_30
    buffer_load_dwordx4 v[244:247], v254, s[8:11], s31 offen sc1
    s_waitcnt vmcnt(1)
    v_min3_u32 v248, v248, v249, v250
    v_min_u32 v248, v248, v251
    v_cmp_gt_u32 vcc, s62, v248
    s_cbranch_scc1 L_polld_30
    s_nop 0
    s_cbranch_vccnz L_poll_29
L_polld_30:
    s_mov_b64 exec, -1
L_w0_28:
    s_barrier
    s_mov_b32 m0, s38
    s_add_u32 s39, s46, s35
    buffer_load_dwordx4 v3, s[8:11], s39 offen sc1 lds
    buffer_load_dwordx4 v[8:11], v3, s[8:11], s40 offen sc1
    buffer_load_dwordx4 v3, s[8:11], s39 offen offset:1024 sc1 lds
    buffer_load_dwordx4 v[12:15], v3, s[8:11], s41 offen sc1
    buffer_load_dwordx4 v[16:19], v3, s[8:11], s42 offen sc1
    buffer_load_dwordx4 v[20:23], v3, s[8:11], s43 offen sc1
    buffer_load_dwordx4 v3, s[8:11], s39 offen offset:2048 sc1 lds
    buffer_load_dwordx4 v3, s[8:11], s39 offen offset:3072 sc1 lds
    s_lshl_b32 s37, s33, 12
    v_add_u32 v160, s37, v3
    v_lshrrev_b32 v2, 5, v1
    v_lshlrev_b32 v162, 8, v2
    v_and_b32 v2, 15, v1
    v_lshl_add_u32 v162, v2, 4, v162
    v_add_u32 v159, 1024, v162
    v_add_u32 v162, s37, v159
    s_mov_b32 s44, 0x0000ffff
    s_mov_b32 s45, 0x0000ffff
    v_and_b32 v2, 27, v1
    v_cmp_eq_u32 vcc, 16, v2
    v_mov_b32 v152, 0x3f803f80
    s_nop 0
    v_cndmask_b32 v152, 0, v152, vcc
    v_mov_b32 v32, v152
    v_mov_b32 v33, v152
    v_mov_b32 v34, v152
    v_mov_b32 v35, v152
    v_mov_b32 v36, v152
    v_mov_b32 v37, v152
    v_mov_b32 v38, v152
    v_mov_b32 v39, v152
    v_mov_b32 v40, v152
    v_mov_b32 v41, v152
    v_mov_b32 v42, v152
    v_mov_b32 v43, v152
    v_mov_b32 v44, v152
    v_mov_b32 v45, v152
    v_mov_b32 v46, v152
    v_mov_b32 v47, v152
    s_lshl_b32 s54, s30, 2
    s_lshl_b32 s55, s18, 14
    s_add_u32 s55, s55, s54
    s_add_u32 s54, s54, 16384
    s_add_u32 s55, s55, 16384
    s_and_b32 s55, s55, 0x1ffff
    s_waitcnt vmcnt(5)
    ds_read_b128 v[24:27], v160 offset:0
    s_mov_b64 exec, s[44:45]
    ds_read_b128 v[32:35], v162 offset:0
    ds_read_b128 v[36:39], v162 offset:512
    s_mov_b64 exec, -1
    s_waitcnt lgkmcnt(0)
    v_mfma_f32_32x32x16_bf16 v[56:71], v[24:27], v[8:11], 0
    s_nop 7
    s_nop 3
    s_waitcnt vmcnt(2)
    s_cmp_ge_u32 s16, 4
    s_cbranch_scc1 L_yc_31
L_yb_32:
    v_mfma_f32_32x32x16_bf16 v[72:87], v[24:27], v[12:15], 0
    v_exp_f32 v56, v56
    v_exp_f32 v57, v57
    v_exp_f32 v58, v58
    v_exp_f32 v59, v59
    v_exp_f32 v60, v60
    v_exp_f32 v61, v61
    v_exp_f32 v62, v62
    v_exp_f32 v63, v63
    v_cvt_pk_bf16_f32 v48, v56, v57
    v_cvt_pk_bf16_f32 v49, v58, v59
    v_exp_f32 v64, v64
    v_cvt_pk_bf16_f32 v50, v60, v61
    v_exp_f32 v65, v65
    v_cvt_pk_bf16_f32 v51, v62, v63
    v_exp_f32 v66, v66
    v_exp_f32 v67, v67
    v_mfma_f32_32x32x16_bf16 v[88:103], v[32:35], v[48:51], 0
    v_exp_f32 v68, v68
    v_exp_f32 v69, v69
    v_cvt_pk_bf16_f32 v52, v64, v65
    v_exp_f32 v70, v70
    v_exp_f32 v71, v71
    v_cvt_pk_bf16_f32 v53, v66, v67
    v_cvt_pk_bf16_f32 v54, v68, v69
    v_cvt_pk_bf16_f32 v55, v70, v71
    v_mfma_f32_32x32x16_bf16 v[56:71], v[24:27], v[16:19], 0
    v_exp_f32 v72, v72
    v_exp_f32 v73, v73
    v_exp_f32 v74, v74
    v_exp_f32 v75, v75
    v_exp_f32 v76, v76
    v_exp_f32 v77, v77
    v_mfma_f32_32x32x16_bf16 v[88:103], v[36:39], v[52:55], v[88:103]
    v_exp_f32 v78, v78
    v_exp_f32 v79, v79
    v_cvt_pk_bf16_f32 v48, v72, v73
    v_cvt_pk_bf16_f32 v49, v74, v75
    v_exp_f32 v80, v80
    v_cvt_pk_bf16_f32 v50, v76, v77
    v_exp_f32 v81, v81
    v_cvt_pk_bf16_f32 v51, v78, v79
    v_exp_f32 v82, v82
    v_exp_f32 v83, v83
    v_mfma_f32_32x32x16_bf16 v[104:119], v[32:35], v[48:51], 0
    v_exp_f32 v84, v84
    v_exp_f32 v85, v85
    v_cvt_pk_bf16_f32 v52, v80, v81
    v_exp_f32 v86, v86
    v_exp_f32 v87, v87
    v_cvt_pk_bf16_f32 v53, v82, v83
    v_cvt_pk_bf16_f32 v54, v84, v85
    v_cvt_pk_bf16_f32 v55, v86, v87
    s_cmp_ge_u32 s16, 4
    s_cbranch_scc1 L_old_35
    s_waitcnt vmcnt(0)
L_old_35:
    v_mfma_f32_32x32x16_bf16 v[72:87], v[24:27], v[20:23], 0
    ds_read_b128 v[28:31], v160 offset:2048
    v_exp_f32 v56, v56
    v_exp_f32 v57, v57
    v_exp_f32 v58, v58
    v_exp_f32 v59, v59
    v_exp_f32 v60, v60
    v_exp_f32 v61, v61
    v_mfma_f32_32x32x16_bf16 v[104:119], v[36:39], v[52:55], v[104:119]
    s_mov_b64 exec, s[44:45]
    ds_read_b128 v[40:43], v162 offset:2048
    ds_read_b128 v[44:47], v162 offset:2560
    s_mov_b64 exec, -1
    v_exp_f32 v62, v62
    v_exp_f32 v63, v63
    v_cvt_pk_bf16_f32 v48, v56, v57
    v_cvt_pk_bf16_f32 v49, v58, v59
    v_exp_f32 v64, v64
    v_cvt_pk_bf16_f32 v50, v60, v61
    v_exp_f32 v65, v65
    v_cvt_pk_bf16_f32 v51, v62, v63
    v_exp_f32 v66, v66
    v_exp_f32 v67, v67
    v_mfma_f32_32x32x16_bf16 v[120:135], v[32:35], v[48:51], 0
    v_exp_f32 v68, v68
    v_exp_f32 v69, v69
    v_cvt_pk_bf16_f32 v52, v64, v65
    v_exp_f32 v70, v70
    v_exp_f32 v71, v71
    v_cvt_pk_bf16_f32 v53, v66, v67
    v_cvt_pk_bf16_f32 v54, v68, v69
    v_cvt_pk_bf16_f32 v55, v70, v71
    s_cmp_ge_u32 s16, 4
    s_cbranch_scc1 L_rl0_36
    s_lshl_b32 s60, s18, 3
    s_and_b32 s61, s19, 3
    s_lshl_b32 s61, s61, 1
    s_add_u32 s60, s60, s61
    s_and_b32 s61, s16, 1
    s_add_u32 s60, s60, s61
    s_lshl_b32 s60, s60, 15
    s_lshr_b32 s61, s19, 2
    s_lshl_b32 s61, s61, 1
    s_lshr_b32 s62, s16, 1
    s_add_u32 s61, s61, s62
    s_cmp_eq_u32 s24, 0
    s_cbranch_scc1 L_rl1_37
    s_lshl_b32 s61, s61, 11
    s_add_u32 s60, s60, s61
    s_add_u32 s60, s60, s79
    buffer_load_dwordx4 v[236:239], v3, s[8:11], s60 offen sc1
    buffer_load_dwordx4 v[240:243], v3, s[8:11], s60 offen offset:1024 sc1
    s_branch L_rl0_36
L_rl1_37:
    s_load_dwordx2 s[64:65], s[0:1], 0
    s_mov_b32 s66, 2097152
    s_mov_b32 s67, 0x00020000
    v_and_b32 v2, 31, v1
    v_lshlrev_b32 v2, 10, v2
    v_lshrrev_b32 v167, 5, v1
    v_lshl_add_u32 v2, v167, 3, v2
    s_lshl_b32 s61, s61, 6
    s_add_u32 s60, s60, s61
    s_waitcnt lgkmcnt(0)
    buffer_load_dwordx2 v[236:237], v2, s[64:67], s60 offen offset:0
    buffer_load_dwordx2 v[238:239], v2, s[64:67], s60 offen offset:16
    buffer_load_dwordx2 v[240:241], v2, s[64:67], s60 offen offset:32
    buffer_load_dwordx2 v[242:243], v2, s[64:67], s60 offen offset:48
L_rl0_36:
    s_waitcnt lgkmcnt(0)
    v_mfma_f32_32x32x16_bf16 v[56:71], v[28:31], v[8:11], 0
    v_exp_f32 v72, v72
    v_exp_f32 v73, v73
    v_exp_f32 v74, v74
    v_exp_f32 v75, v75
    v_exp_f32 v76, v76
    v_exp_f32 v77, v77
    v_mfma_f32_32x32x16_bf16 v[120:135], v[36:39], v[52:55], v[120:135]
    v_exp_f32 v78, v78
    v_exp_f32 v79, v79
    v_cvt_pk_bf16_f32 v48, v72, v73
    v_cvt_pk_bf16_f32 v49, v74, v75
    v_exp_f32 v80, v80
    v_cvt_pk_bf16_f32 v50, v76, v77
    v_exp_f32 v81, v81
    v_cvt_pk_bf16_f32 v51, v78, v79
    v_exp_f32 v82, v82
    v_exp_f32 v83, v83
    v_mfma_f32_32x32x16_bf16 v[136:151], v[32:35], v[48:51], 0
    v_exp_f32 v84, v84
    v_exp_f32 v85, v85
    v_cvt_pk_bf16_f32 v52, v80, v81
    v_exp_f32 v86, v86
    v_exp_f32 v87, v87
    v_cvt_pk_bf16_f32 v53, v82, v83
    v_cvt_pk_bf16_f32 v54, v84, v85
    v_cvt_pk_bf16_f32 v55, v86, v87
    v_mfma_f32_32x32x16_bf16 v[72:87], v[28:31], v[12:15], 0
    v_exp_f32 v56, v56
    v_exp_f32 v57, v57
    v_exp_f32 v58, v58
    v_exp_f32 v59, v59
    v_exp_f32 v60, v60
    v_exp_f32 v61, v61
    v_mfma_f32_32x32x16_bf16 v[136:151], v[36:39], v[52:55], v[136:151]
    v_exp_f32 v62, v62
    v_exp_f32 v63, v63
    v_cvt_pk_bf16_f32 v48, v56, v57
    v_cvt_pk_bf16_f32 v49, v58, v59
    v_exp_f32 v64, v64
    v_cvt_pk_bf16_f32 v50, v60, v61
    v_exp_f32 v65, v65
    v_cvt_pk_bf16_f32 v51, v62, v63
    v_exp_f32 v66, v66
    v_exp_f32 v67, v67
    v_mfma_f32_32x32x16_bf16 v[88:103], v[40:43], v[48:51], v[88:103]
    v_exp_f32 v68, v68
    v_exp_f32 v69, v69
    v_cvt_pk_bf16_f32 v52, v64, v65
    v_exp_f32 v70, v70
    v_exp_f32 v71, v71
    v_cvt_pk_bf16_f32 v53, v66, v67
    v_cvt_pk_bf16_f32 v54, v68, v69
    v_cvt_pk_bf16_f32 v55, v70, v71
    v_mfma_f32_32x32x16_bf16 v[56:71], v[28:31], v[16:19], 0
    v_exp_f32 v72, v72
    v_exp_f32 v73, v73
    v_exp_f32 v74, v74
    v_exp_f32 v75, v75
    v_exp_f32 v76, v76
    v_exp_f32 v77, v77
    v_mfma_f32_32x32x16_bf16 v[88:103], v[44:47], v[52:55], v[88:103]
    v_exp_f32 v78, v78
    v_exp_f32 v79, v79
    v_cvt_pk_bf16_f32 v48, v72, v73
    v_cvt_pk_bf16_f32 v49, v74, v75
    v_exp_f32 v80, v80
    v_cvt_pk_bf16_f32 v50, v76, v77
    v_exp_f32 v81, v81
    v_cvt_pk_bf16_f32 v51, v78, v79
    v_exp_f32 v82, v82
    v_exp_f32 v83, v83
    v_mfma_f32_32x32x16_bf16 v[104:119], v[40:43], v[48:51], v[104:119]
    v_exp_f32 v84, v84
    v_exp_f32 v85, v85
    v_cvt_pk_bf16_f32 v52, v80, v81
    v_exp_f32 v86, v86
    v_exp_f32 v87, v87
    v_cvt_pk_bf16_f32 v53, v82, v83
    v_cvt_pk_bf16_f32 v54, v84, v85
    v_cvt_pk_bf16_f32 v55, v86, v87
    s_waitcnt vmcnt(0)
    s_barrier
    s_cmp_ge_u32 s16, 4
    s_cbranch_scc1 L_yc_38
L_yb_39:
    v_mfma_f32_32x32x16_bf16 v[72:87], v[28:31], v[20:23], 0
    ds_read_b128 v[24:27], v160 offset:16384
    v_exp_f32 v56, v56
    v_exp_f32 v57, v57
    v_exp_f32 v58, v58
    v_exp_f32 v59, v59
    v_exp_f32 v60, v60
    v_exp_f32 v61, v61
    v_mfma_f32_32x32x16_bf16 v[104:119], v[44:47], v[52:55], v[104:119]
    s_mov_b64 exec, s[44:45]
    ds_read_b128 v[32:35], v162 offset:16384
    ds_read_b128 v[36:39], v162 offset:16896
    s_mov_b64 exec, -1
    v_exp_f32 v62, v62
    v_exp_f32 v63, v63
    v_cvt_pk_bf16_f32 v48, v56, v57
    v_cvt_pk_bf16_f32 v49, v58, v59
    v_exp_f32 v64, v64
    v_cvt_pk_bf16_f32 v50, v60, v61
    v_exp_f32 v65, v65
    v_cvt_pk_bf16_f32 v51, v62, v63
    v_exp_f32 v66, v66
    v_exp_f32 v67, v67
    v_mfma_f32_32x32x16_bf16 v[120:135], v[40:43], v[48:51], v[120:135]
    v_exp_f32 v68, v68
    v_exp_f32 v69, v69
    v_cvt_pk_bf16_f32 v52, v64, v65
    v_exp_f32 v70, v70
    v_exp_f32 v71, v71
    v_cvt_pk_bf16_f32 v53, v66, v67
    v_cvt_pk_bf16_f32 v54, v68, v69
    v_cvt_pk_bf16_f32 v55, v70, v71
    s_waitcnt lgkmcnt(0)
    v_mfma_f32_32x32x16_bf16 v[56:71], v[24:27], v[8:11], 0
    v_exp_f32 v72, v72
    v_exp_f32 v73, v73
    v_exp_f32 v74, v74
    v_exp_f32 v75, v75
    v_exp_f32 v76, v76
    v_exp_f32 v77, v77
    v_mfma_f32_32x32x16_bf16 v[120:135], v[44:47], v[52:55], v[120:135]
    v_exp_f32 v78, v78
    v_exp_f32 v79, v79
    v_cvt_pk_bf16_f32 v48, v72, v73
    v_cvt_pk_bf16_f32 v49, v74, v75
    v_exp_f32 v80, v80
    v_cvt_pk_bf16_f32 v50, v76, v77
    v_exp_f32 v81, v81
    v_cvt_pk_bf16_f32 v51, v78, v79
    v_exp_f32 v82, v82
    v_exp_f32 v83, v83
    v_mfma_f32_32x32x16_bf16 v[136:151], v[40:43], v[48:51], v[136:151]
    v_exp_f32 v84, v84
    v_exp_f32 v85, v85
    v_cvt_pk_bf16_f32 v52, v80, v81
    v_exp_f32 v86, v86
    v_exp_f32 v87, v87
    v_cvt_pk_bf16_f32 v53, v82, v83
    v_cvt_pk_bf16_f32 v54, v84, v85
    v_cvt_pk_bf16_f32 v55, v86, v87
    v_add_u32 v160, 0x4000, v160
    v_add_u32 v162, 0x4000, v162
    s_mov_b32 s56, 1
    s_mul_i32 s57, s24, 5
    s_sub_u32 s58, 1, s24
L_aloop_53:
    v_mfma_f32_32x32x16_bf16 v[72:87], v[24:27], v[12:15], 0
    v_exp_f32 v56, v56
    v_exp_f32 v57, v57
    v_exp_f32 v58, v58
    v_exp_f32 v59, v59
    v_exp_f32 v60, v60
    v_exp_f32 v61, v61
    v_mfma_f32_32x32x16_bf16 v[136:151], v[44:47], v[52:55], v[136:151]
    v_exp_f32 v62, v62
    v_exp_f32 v63, v63
    v_cvt_pk_bf16_f32 v48, v56, v57
    v_cvt_pk_bf16_f32 v49, v58, v59
    v_exp_f32 v64, v64
    v_cvt_pk_bf16_f32 v50, v60, v61
    v_exp_f32 v65, v65
    v_cvt_pk_bf16_f32 v51, v62, v63
    v_exp_f32 v66, v66
    v_exp_f32 v67, v67
    v_mfma_f32_32x32x16_bf16 v[88:103], v[32:35], v[48:51], v[88:103]
    v_exp_f32 v68, v68
    v_exp_f32 v69, v69
    v_cvt_pk_bf16_f32 v52, v64, v65
    v_exp_f32 v70, v70
    v_exp_f32 v71, v71
    v_cvt_pk_bf16_f32 v53, v66, v67
    v_cvt_pk_bf16_f32 v54, v68, v69
    v_cvt_pk_bf16_f32 v55, v70, v71
    v_mfma_f32_32x32x16_bf16 v[56:71], v[24:27], v[16:19], 0
    v_exp_f32 v72, v72
    v_exp_f32 v73, v73
    v_exp_f32 v74, v74
    v_exp_f32 v75, v75
    v_exp_f32 v76, v76
    v_exp_f32 v77, v77
    v_mfma_f32_32x32x16_bf16 v[88:103], v[36:39], v[52:55], v[88:103]
    v_exp_f32 v78, v78
    v_exp_f32 v79, v79
    v_cvt_pk_bf16_f32 v48, v72, v73
    v_cvt_pk_bf16_f32 v49, v74, v75
    v_exp_f32 v80, v80
    v_cvt_pk_bf16_f32 v50, v76, v77
    v_exp_f32 v81, v81
    v_cvt_pk_bf16_f32 v51, v78, v79
    v_exp_f32 v82, v82
    v_exp_f32 v83, v83
    v_mfma_f32_32x32x16_bf16 v[104:119], v[32:35], v[48:51], v[104:119]
    v_exp_f32 v84, v84
    v_exp_f32 v85, v85
    v_cvt_pk_bf16_f32 v52, v80, v81
    v_exp_f32 v86, v86
    v_exp_f32 v87, v87
    v_cvt_pk_bf16_f32 v53, v82, v83
    v_cvt_pk_bf16_f32 v54, v84, v85
    v_cvt_pk_bf16_f32 v55, v86, v87
    v_mfma_f32_32x32x16_bf16 v[72:87], v[24:27], v[20:23], 0
    ds_read_b128 v[28:31], v160 offset:2048
    v_exp_f32 v56, v56
    v_exp_f32 v57, v57
    v_exp_f32 v58, v58
    v_exp_f32 v59, v59
    v_exp_f32 v60, v60
    v_exp_f32 v61, v61
    v_mfma_f32_32x32x16_bf16 v[104:119], v[36:39], v[52:55], v[104:119]
    s_mov_b64 exec, s[44:45]
    ds_read_b128 v[40:43], v162 offset:2048
    ds_read_b128 v[44:47], v162 offset:2560
    s_mov_b64 exec, -1
    v_exp_f32 v62, v62
    v_exp_f32 v63, v63
    v_cvt_pk_bf16_f32 v48, v56, v57
    v_cvt_pk_bf16_f32 v49, v58, v59
    v_exp_f32 v64, v64
    v_cvt_pk_bf16_f32 v50, v60, v61
    v_exp_f32 v65, v65
    v_cvt_pk_bf16_f32 v51, v62, v63
    v_exp_f32 v66, v66
    v_exp_f32 v67, v67
    v_mfma_f32_32x32x16_bf16 v[120:135], v[32:35], v[48:51], v[120:135]
    v_exp_f32 v68, v68
    v_exp_f32 v69, v69
    v_cvt_pk_bf16_f32 v52, v64, v65
    v_exp_f32 v70, v70
    v_exp_f32 v71, v71
    v_cvt_pk_bf16_f32 v53, v66, v67
    v_cvt_pk_bf16_f32 v54, v68, v69
    v_cvt_pk_bf16_f32 v55, v70, v71
    s_waitcnt lgkmcnt(0)
    v_mfma_f32_32x32x16_bf16 v[56:71], v[28:31], v[8:11], 0
    v_exp_f32 v72, v72
    v_exp_f32 v73, v73
    v_exp_f32 v74, v74
    v_exp_f32 v75, v75
    v_exp_f32 v76, v76
    v_exp_f32 v77, v77
    v_mfma_f32_32x32x16_bf16 v[120:135], v[36:39], v[52:55], v[120:135]
    v_exp_f32 v78, v78
    v_exp_f32 v79, v79
    v_cvt_pk_bf16_f32 v48, v72, v73
    v_cvt_pk_bf16_f32 v49, v74, v75
    v_exp_f32 v80, v80
    v_cvt_pk_bf16_f32 v50, v76, v77
    v_exp_f32 v81, v81
    v_cvt_pk_bf16_f32 v51, v78, v79
    v_exp_f32 v82, v82
    v_exp_f32 v83, v83
    v_mfma_f32_32x32x16_bf16 v[136:151], v[32:35], v[48:51], v[136:151]
    v_exp_f32 v84, v84
    v_exp_f32 v85, v85
    v_cvt_pk_bf16_f32 v52, v80, v81
    v_exp_f32 v86, v86
    v_exp_f32 v87, v87
    v_cvt_pk_bf16_f32 v53, v82, v83
    v_cvt_pk_bf16_f32 v54, v84, v85
    v_cvt_pk_bf16_f32 v55, v86, v87
    v_mfma_f32_32x32x16_bf16 v[72:87], v[28:31], v[12:15], 0
    v_exp_f32 v56, v56
    v_exp_f32 v57, v57
    v_exp_f32 v58, v58
    v_exp_f32 v59, v59
    v_exp_f32 v60, v60
    v_exp_f32 v61, v61
    v_mfma_f32_32x32x16_bf16 v[136:151], v[36:39], v[52:55], v[136:151]
    v_exp_f32 v62, v62
    v_exp_f32 v63, v63
    v_cvt_pk_bf16_f32 v48, v56, v57
    v_cvt_pk_bf16_f32 v49, v58, v59
    v_exp_f32 v64, v64
    v_cvt_pk_bf16_f32 v50, v60, v61
    v_exp_f32 v65, v65
    v_cvt_pk_bf16_f32 v51, v62, v63
    v_exp_f32 v66, v66
    v_exp_f32 v67, v67
    v_mfma_f32_32x32x16_bf16 v[88:103], v[40:43], v[48:51], v[88:103]
    v_exp_f32 v68, v68
    v_exp_f32 v69, v69
    v_cvt_pk_bf16_f32 v52, v64, v65
    v_exp_f32 v70, v70
    v_exp_f32 v71, v71
    v_cvt_pk_bf16_f32 v53, v66, v67
    v_cvt_pk_bf16_f32 v54, v68, v69
    v_cvt_pk_bf16_f32 v55, v70, v71
    v_mfma_f32_32x32x16_bf16 v[56:71], v[28:31], v[16:19], 0
    v_exp_f32 v72, v72
    v_exp_f32 v73, v73
    v_exp_f32 v74, v74
    v_exp_f32 v75, v75
    v_exp_f32 v76, v76
    v_exp_f32 v77, v77
    v_mfma_f32_32x32x16_bf16 v[88:103], v[44:47], v[52:55], v[88:103]
    v_exp_f32 v78, v78
    v_exp_f32 v79, v79
    v_cvt_pk_bf16_f32 v48, v72, v73
    v_cvt_pk_bf16_f32 v49, v74, v75
    v_exp_f32 v80, v80
    v_cvt_pk_bf16_f32 v50, v76, v77
    v_exp_f32 v81, v81
    v_cvt_pk_bf16_f32 v51, v78, v79
    v_exp_f32 v82, v82
    v_exp_f32 v83, v83
    v_mfma_f32_32x32x16_bf16 v[104:119], v[40:43], v[48:51], v[104:119]
    v_exp_f32 v84, v84
    v_exp_f32 v85, v85
    v_cvt_pk_bf16_f32 v52, v80, v81
    v_exp_f32 v86, v86
    v_exp_f32 v87, v87
    v_cvt_pk_bf16_f32 v53, v82, v83
    v_cvt_pk_bf16_f32 v54, v84, v85
    v_cvt_pk_bf16_f32 v55, v86, v87
    s_waitcnt vmcnt(16)
    s_cmp_lg_u32 s56, s57
    s_cbranch_scc0 L_aw_54
    s_waitcnt vmcnt(8)
    s_cmp_lg_u32 s56, s58
    s_cbranch_scc0 L_aw_54
    s_waitcnt vmcnt(0)
L_aw_54:
    s_barrier
    s_cmp_ge_u32 s16, 4
    s_cbranch_scc1 L_yc_55
L_yb_56:
    v_mfma_f32_32x32x16_bf16 v[72:87], v[28:31], v[20:23], 0
    ds_read_b128 v[24:27], v160 offset:16384
    v_exp_f32 v56, v56
    v_exp_f32 v57, v57
    v_exp_f32 v58, v58
    v_exp_f32 v59, v59
    v_exp_f32 v60, v60
    v_exp_f32 v61, v61
    v_mfma_f32_32x32x16_bf16 v[104:119], v[44:47], v[52:55], v[104:119]
    s_mov_b64 exec, s[44:45]
    ds_read_b128 v[32:35], v162 offset:16384
    ds_read_b128 v[36:39], v162 offset:16896
    s_mov_b64 exec, -1
    v_exp_f32 v62, v62
    v_exp_f32 v63, v63
    v_cvt_pk_bf16_f32 v48, v56, v57
    v_cvt_pk_bf16_f32 v49, v58, v59
    v_exp_f32 v64, v64
    v_cvt_pk_bf16_f32 v50, v60, v61
    v_exp_f32 v65, v65
    v_cvt_pk_bf16_f32 v51, v62, v63
    v_exp_f32 v66, v66
    v_exp_f32 v67, v67
    v_mfma_f32_32x32x16_bf16 v[120:135], v[40:43], v[48:51], v[120:135]
    v_exp_f32 v68, v68
    v_exp_f32 v69, v69
    v_cvt_pk_bf16_f32 v52, v64, v65
    v_exp_f32 v70, v70
    v_exp_f32 v71, v71
    v_cvt_pk_bf16_f32 v53, v66, v67
    v_cvt_pk_bf16_f32 v54, v68, v69
    v_cvt_pk_bf16_f32 v55, v70, v71
    s_waitcnt lgkmcnt(0)
    v_mfma_f32_32x32x16_bf16 v[56:71], v[24:27], v[8:11], 0
    v_exp_f32 v72, v72
    v_exp_f32 v73, v73
    v_exp_f32 v74, v74
    v_exp_f32 v75, v75
    v_exp_f32 v76, v76
    v_exp_f32 v77, v77
    v_mfma_f32_32x32x16_bf16 v[120:135], v[44:47], v[52:55], v[120:135]
    v_exp_f32 v78, v78
    v_exp_f32 v79, v79
    v_cvt_pk_bf16_f32 v48, v72, v73
    v_cvt_pk_bf16_f32 v49, v74, v75
    v_exp_f32 v80, v80
    v_cvt_pk_bf16_f32 v50, v76, v77
    v_exp_f32 v81, v81
    v_cvt_pk_bf16_f32 v51, v78, v79
    v_exp_f32 v82, v82
    v_exp_f32 v83, v83
    v_mfma_f32_32x32x16_bf16 v[136:151], v[40:43], v[48:51], v[136:151]
    v_exp_f32 v84, v84
    v_exp_f32 v85, v85
    v_cvt_pk_bf16_f32 v52, v80, v81
    v_exp_f32 v86, v86
    v_exp_f32 v87, v87
    v_cvt_pk_bf16_f32 v53, v82, v83
    v_cvt_pk_bf16_f32 v54, v84, v85
    v_cvt_pk_bf16_f32 v55, v86, v87
    v_mfma_f32_32x32x16_bf16 v[72:87], v[24:27], v[12:15], 0
    v_exp_f32 v56, v56
    v_exp_f32 v57, v57
    v_exp_f32 v58, v58
    v_exp_f32 v59, v59
    v_exp_f32 v60, v60
    v_exp_f32 v61, v61
    v_mfma_f32_32x32x16_bf16 v[136:151], v[44:47], v[52:55], v[136:151]
    v_exp_f32 v62, v62
    v_exp_f32 v63, v63
    v_cvt_pk_bf16_f32 v48, v56, v57
    v_cvt_pk_bf16_f32 v49, v58, v59
    v_exp_f32 v64, v64
    v_cvt_pk_bf16_f32 v50, v60, v61
    v_exp_f32 v65, v65
    v_cvt_pk_bf16_f32 v51, v62, v63
    v_exp_f32 v66, v66
    v_exp_f32 v67, v67
    v_mfma_f32_32x32x16_bf16 v[88:103], v[32:35], v[48:51], v[88:103]
    v_exp_f32 v68, v68
    v_exp_f32 v69, v69
    v_cvt_pk_bf16_f32 v52, v64, v65
    v_exp_f32 v70, v70
    v_exp_f32 v71, v71
    v_cvt_pk_bf16_f32 v53, v66, v67
    v_cvt_pk_bf16_f32 v54, v68, v69
    v_cvt_pk_bf16_f32 v55, v70, v71
    v_mfma_f32_32x32x16_bf16 v[56:71], v[24:27], v[16:19], 0
    v_exp_f32 v72, v72
    v_exp_f32 v73, v73
    v_exp_f32 v74, v74
    v_exp_f32 v75, v75
    v_exp_f32 v76, v76
    v_exp_f32 v77, v77
    v_mfma_f32_32x32x16_bf16 v[88:103], v[36:39], v[52:55], v[88:103]
    v_exp_f32 v78, v78
    v_exp_f32 v79, v79
    v_cvt_pk_bf16_f32 v48, v72, v73
    v_cvt_pk_bf16_f32 v49, v74, v75
    v_exp_f32 v80, v80
    v_cvt_pk_bf16_f32 v50, v76, v77
    v_exp_f32 v81, v81
    v_cvt_pk_bf16_f32 v51, v78, v79
    v_exp_f32 v82, v82
    v_exp_f32 v83, v83
    v_mfma_f32_32x32x16_bf16 v[104:119], v[32:35], v[48:51], v[104:119]
    v_exp_f32 v84, v84
    v_exp_f32 v85, v85
    v_cvt_pk_bf16_f32 v52, v80, v81
    v_exp_f32 v86, v86
    v_exp_f32 v87, v87
    v_cvt_pk_bf16_f32 v53, v82, v83
    v_cvt_pk_bf16_f32 v54, v84, v85
    v_cvt_pk_bf16_f32 v55, v86, v87
    v_mfma_f32_32x32x16_bf16 v[72:87], v[24:27], v[20:23], 0
    ds_read_b128 v[28:31], v160 offset:18432
    v_exp_f32 v56, v56
    v_exp_f32 v57, v57
    v_exp_f32 v58, v58
    v_exp_f32 v59, v59
    v_exp_f32 v60, v60
    v_exp_f32 v61, v61
    v_mfma_f32_32x32x16_bf16 v[104:119], v[36:39], v[52:55], v[104:119]
    s_mov_b64 exec, s[44:45]
    ds_read_b128 v[40:43], v162 offset:18432
    ds_read_b128 v[44:47], v162 offset:18944
    s_mov_b64 exec, -1
    v_exp_f32 v62, v62
    v_exp_f32 v63, v63
    v_cvt_pk_bf16_f32 v48, v56, v57
    v_cvt_pk_bf16_f32 v49, v58, v59
    v_exp_f32 v64, v64
    v_cvt_pk_bf16_f32 v50, v60, v61
    v_exp_f32 v65, v65
    v_cvt_pk_bf16_f32 v51, v62, v63
    v_exp_f32 v66, v66
    v_exp_f32 v67, v67
    v_mfma_f32_32x32x16_bf16 v[120:135], v[32:35], v[48:51], v[120:135]
    v_exp_f32 v68, v68
    v_exp_f32 v69, v69
    v_cvt_pk_bf16_f32 v52, v64, v65
    v_exp_f32 v70, v70
    v_exp_f32 v71, v71
    v_cvt_pk_bf16_f32 v53, v66, v67
    v_cvt_pk_bf16_f32 v54, v68, v69
    v_cvt_pk_bf16_f32 v55, v70, v71
    s_waitcnt lgkmcnt(0)
    v_mfma_f32_32x32x16_bf16 v[56:71], v[28:31], v[8:11], 0
    v_exp_f32 v72, v72
    v_exp_f32 v73, v73
    v_exp_f32 v74, v74
    v_exp_f32 v75, v75
    v_exp_f32 v76, v76
    v_exp_f32 v77, v77
    v_mfma_f32_32x32x16_bf16 v[120:135], v[36:39], v[52:55], v[120:135]
    v_exp_f32 v78, v78
    v_exp_f32 v79, v79
    v_cvt_pk_bf16_f32 v48, v72, v73
    v_cvt_pk_bf16_f32 v49, v74, v75
    v_exp_f32 v80, v80
    v_cvt_pk_bf16_f32 v50, v76, v77
    v_exp_f32 v81, v81
    v_cvt_pk_bf16_f32 v51, v78, v79
    v_exp_f32 v82, v82
    v_exp_f32 v83, v83
    v_mfma_f32_32x32x16_bf16 v[136:151], v[32:35], v[48:51], v[136:151]
    v_exp_f32 v84, v84
    v_exp_f32 v85, v85
    v_cvt_pk_bf16_f32 v52, v80, v81
    v_exp_f32 v86, v86
    v_exp_f32 v87, v87
    v_cvt_pk_bf16_f32 v53, v82, v83
    v_cvt_pk_bf16_f32 v54, v84, v85
    v_cvt_pk_bf16_f32 v55, v86, v87
    v_mfma_f32_32x32x16_bf16 v[72:87], v[28:31], v[12:15], 0
    v_exp_f32 v56, v56
    v_exp_f32 v57, v57
    v_exp_f32 v58, v58
    v_exp_f32 v59, v59
    v_exp_f32 v60, v60
    v_exp_f32 v61, v61
    v_mfma_f32_32x32x16_bf16 v[136:151], v[36:39], v[52:55], v[136:151]
    v_exp_f32 v62, v62
    v_exp_f32 v63, v63
    v_cvt_pk_bf16_f32 v48, v56, v57
    v_cvt_pk_bf16_f32 v49, v58, v59
    v_exp_f32 v64, v64
    v_cvt_pk_bf16_f32 v50, v60, v61
    v_exp_f32 v65, v65
    v_cvt_pk_bf16_f32 v51, v62, v63
    v_exp_f32 v66, v66
    v_exp_f32 v67, v67
    v_mfma_f32_32x32x16_bf16 v[88:103], v[40:43], v[48:51], v[88:103]
    v_exp_f32 v68, v68
    v_exp_f32 v69, v69
    v_cvt_pk_bf16_f32 v52, v64, v65
    v_exp_f32 v70, v70
    v_exp_f32 v71, v71
    v_cvt_pk_bf16_f32 v53, v66, v67
    v_cvt_pk_bf16_f32 v54, v68, v69
    v_cvt_pk_bf16_f32 v55, v70, v71
    v_mfma_f32_32x32x16_bf16 v[56:71], v[28:31], v[16:19], 0
    v_exp_f32 v72, v72
    v_exp_f32 v73, v73
    v_exp_f32 v74, v74
    v_exp_f32 v75, v75
    v_exp_f32 v76, v76
    v_exp_f32 v77, v77
    v_mfma_f32_32x32x16_bf16 v[88:103], v[44:47], v[52:55], v[88:103]
    v_exp_f32 v78, v78
    v_exp_f32 v79, v79
    v_cvt_pk_bf16_f32 v48, v72, v73
    v_cvt_pk_bf16_f32 v49, v74, v75
    v_exp_f32 v80, v80
    v_cvt_pk_bf16_f32 v50, v76, v77
    v_exp_f32 v81, v81
    v_cvt_pk_bf16_f32 v51, v78, v79
    v_exp_f32 v82, v82
    v_exp_f32 v83, v83
    v_mfma_f32_32x32x16_bf16 v[104:119], v[40:43], v[48:51], v[104:119]
    v_exp_f32 v84, v84
    v_exp_f32 v85, v85
    v_cvt_pk_bf16_f32 v52, v80, v81
    v_exp_f32 v86, v86
    v_exp_f32 v87, v87
    v_cvt_pk_bf16_f32 v53, v82, v83
    v_cvt_pk_bf16_f32 v54, v84, v85
    v_cvt_pk_bf16_f32 v55, v86, v87
    v_mfma_f32_32x32x16_bf16 v[72:87], v[28:31], v[20:23], 0
    ds_read_b128 v[24:27], v160 offset:32768
    v_exp_f32 v56, v56
    v_exp_f32 v57, v57
    v_exp_f32 v58, v58
    v_exp_f32 v59, v59
    v_exp_f32 v60, v60
    v_exp_f32 v61, v61
    v_mfma_f32_32x32x16_bf16 v[104:119], v[44:47], v[52:55], v[104:119]
    s_mov_b64 exec, s[44:45]
    ds_read_b128 v[32:35], v162 offset:32768
    ds_read_b128 v[36:39], v162 offset:33280
    s_mov_b64 exec, -1
    v_exp_f32 v62, v62
    v_exp_f32 v63, v63
    v_cvt_pk_bf16_f32 v48, v56, v57
    v_cvt_pk_bf16_f32 v49, v58, v59
    v_exp_f32 v64, v64
    v_cvt_pk_bf16_f32 v50, v60, v61
    v_exp_f32 v65, v65
    v_cvt_pk_bf16_f32 v51, v62, v63
    v_exp_f32 v66, v66
    v_exp_f32 v67, v67
    v_mfma_f32_32x32x16_bf16 v[120:135], v[40:43], v[48:51], v[120:135]
    v_exp_f32 v68, v68
    v_exp_f32 v69, v69
    v_cvt_pk_bf16_f32 v52, v64, v65
    v_exp_f32 v70, v70
    v_exp_f32 v71, v71
    v_cvt_pk_bf16_f32 v53, v66, v67
    v_cvt_pk_bf16_f32 v54, v68, v69
    v_cvt_pk_bf16_f32 v55, v70, v71
    s_waitcnt lgkmcnt(0)
    v_mfma_f32_32x32x16_bf16 v[56:71], v[24:27], v[8:11], 0
    v_exp_f32 v72, v72
    v_exp_f32 v73, v73
    v_exp_f32 v74, v74
    v_exp_f32 v75, v75
    v_exp_f32 v76, v76
    v_exp_f32 v77, v77
    v_mfma_f32_32x32x16_bf16 v[120:135], v[44:47], v[52:55], v[120:135]
    v_exp_f32 v78, v78
    v_exp_f32 v79, v79
    v_cvt_pk_bf16_f32 v48, v72, v73
    v_cvt_pk_bf16_f32 v49, v74, v75
    v_exp_f32 v80, v80
    v_cvt_pk_bf16_f32 v50, v76, v77
    v_exp_f32 v81, v81
    v_cvt_pk_bf16_f32 v51, v78, v79
    v_exp_f32 v82, v82
    v_exp_f32 v83, v83
    v_mfma_f32_32x32x16_bf16 v[136:151], v[40:43], v[48:51], v[136:151]
    v_exp_f32 v84, v84
    v_exp_f32 v85, v85
    v_cvt_pk_bf16_f32 v52, v80, v81
    v_exp_f32 v86, v86
    v_exp_f32 v87, v87
    v_cvt_pk_bf16_f32 v53, v82, v83
    v_cvt_pk_bf16_f32 v54, v84, v85
    v_cvt_pk_bf16_f32 v55, v86, v87
    v_add_u32 v160, 0x8000, v160
    v_add_u32 v162, 0x8000, v162
    s_add_u32 s56, s56, 2
    s_cmp_lt_u32 s56, 7
    s_cbranch_scc1 L_aloop_53
    v_mfma_f32_32x32x16_bf16 v[72:87], v[24:27], v[12:15], 0
    v_exp_f32 v56, v56
    v_exp_f32 v57, v57
    v_exp_f32 v58, v58
    v_exp_f32 v59, v59
    v_exp_f32 v60, v60
    v_exp_f32 v61, v61
    v_mfma_f32_32x32x16_bf16 v[136:151], v[44:47], v[52:55], v[136:151]
    v_exp_f32 v62, v62
    v_exp_f32 v63, v63
    v_cvt_pk_bf16_f32 v48, v56, v57
    v_cvt_pk_bf16_f32 v49, v58, v59
    v_exp_f32 v64, v64
    v_cvt_pk_bf16_f32 v50, v60, v61
    v_exp_f32 v65, v65
    v_cvt_pk_bf16_f32 v51, v62, v63
    v_exp_f32 v66, v66
    v_exp_f32 v67, v67
    v_mfma_f32_32x32x16_bf16 v[88:103], v[32:35], v[48:51], v[88:103]
    v_exp_f32 v68, v68
    v_exp_f32 v69, v69
    v_cvt_pk_bf16_f32 v52, v64, v65
    v_exp_f32 v70, v70
    v_exp_f32 v71, v71
    v_cvt_pk_bf16_f32 v53, v66, v67
    v_cvt_pk_bf16_f32 v54, v68, v69
    v_cvt_pk_bf16_f32 v55, v70, v71
    v_mfma_f32_32x32x16_bf16 v[56:71], v[24:27], v[16:19], 0
    v_exp_f32 v72, v72
    v_exp_f32 v73, v73
    v_exp_f32 v74, v74
    v_exp_f32 v75, v75
    v_exp_f32 v76, v76
    v_exp_f32 v77, v77
    v_mfma_f32_32x32x16_bf16 v[88:103], v[36:39], v[52:55], v[88:103]
    v_exp_f32 v78, v78
    v_exp_f32 v79, v79
    v_cvt_pk_bf16_f32 v48, v72, v73
    v_cvt_pk_bf16_f32 v49, v74, v75
    v_exp_f32 v80, v80
    v_cvt_pk_bf16_f32 v50, v76, v77
    v_exp_f32 v81, v81
    v_cvt_pk_bf16_f32 v51, v78, v79
    v_exp_f32 v82, v82
    v_exp_f32 v83, v83
    v_mfma_f32_32x32x16_bf16 v[104:119], v[32:35], v[48:51], v[104:119]
    v_exp_f32 v84, v84
    v_exp_f32 v85, v85
    v_cvt_pk_bf16_f32 v52, v80, v81
    v_exp_f32 v86, v86
    v_exp_f32 v87, v87
    v_cvt_pk_bf16_f32 v53, v82, v83
    v_cvt_pk_bf16_f32 v54, v84, v85
    v_cvt_pk_bf16_f32 v55, v86, v87
    v_mfma_f32_32x32x16_bf16 v[72:87], v[24:27], v[20:23], 0
    ds_read_b128 v[28:31], v160 offset:2048
    v_exp_f32 v56, v56
    v_exp_f32 v57, v57
    v_exp_f32 v58, v58
    v_exp_f32 v59, v59
    v_exp_f32 v60, v60
    v_exp_f32 v61, v61
    v_mfma_f32_32x32x16_bf16 v[104:119], v[36:39], v[52:55], v[104:119]
    s_mov_b64 exec, s[44:45]
    ds_read_b128 v[40:43], v162 offset:2048
    ds_read_b128 v[44:47], v162 offset:2560
    s_mov_b64 exec, -1
    v_exp_f32 v62, v62
    v_exp_f32 v63, v63
    v_cvt_pk_bf16_f32 v48, v56, v57
    v_cvt_pk_bf16_f32 v49, v58, v59
    v_exp_f32 v64, v64
    v_cvt_pk_bf16_f32 v50, v60, v61
    v_exp_f32 v65, v65
    v_cvt_pk_bf16_f32 v51, v62, v63
    v_exp_f32 v66, v66
    v_exp_f32 v67, v67
    v_mfma_f32_32x32x16_bf16 v[120:135], v[32:35], v[48:51], v[120:135]
    v_exp_f32 v68, v68
    v_exp_f32 v69, v69
    v_cvt_pk_bf16_f32 v52, v64, v65
    v_exp_f32 v70, v70
    v_exp_f32 v71, v71
    v_cvt_pk_bf16_f32 v53, v66, v67
    v_cvt_pk_bf16_f32 v54, v68, v69
    v_cvt_pk_bf16_f32 v55, v70, v71
    s_waitcnt lgkmcnt(0)
    v_mfma_f32_32x32x16_bf16 v[56:71], v[28:31], v[8:11], 0
    v_exp_f32 v72, v72
    v_exp_f32 v73, v73
    v_exp_f32 v74, v74
    v_exp_f32 v75, v75
    v_exp_f32 v76, v76
    v_exp_f32 v77, v77
    v_mfma_f32_32x32x16_bf16 v[120:135], v[36:39], v[52:55], v[120:135]
    v_exp_f32 v78, v78
    v_exp_f32 v79, v79
    v_cvt_pk_bf16_f32 v48, v72, v73
    v_cvt_pk_bf16_f32 v49, v74, v75
    v_exp_f32 v80, v80
    v_cvt_pk_bf16_f32 v50, v76, v77
    v_exp_f32 v81, v81
    v_cvt_pk_bf16_f32 v51, v78, v79
    v_exp_f32 v82, v82
    v_exp_f32 v83, v83
    v_mfma_f32_32x32x16_bf16 v[136:151], v[32:35], v[48:51], v[136:151]
    v_exp_f32 v84, v84
    v_exp_f32 v85, v85
    v_cvt_pk_bf16_f32 v52, v80, v81
    v_exp_f32 v86, v86
    v_exp_f32 v87, v87
    v_cvt_pk_bf16_f32 v53, v82, v83
    v_cvt_pk_bf16_f32 v54, v84, v85
    v_cvt_pk_bf16_f32 v55, v86, v87
    s_cmp_ge_u32 s16, 4
    s_cbranch_scc1 L_old_88
    s_and_b32 s47, s16, 3
    s_mul_i32 s47, s47, 6912
    s_lshr_b32 s49, s16, 2
    s_lshl_b32 s49, s49, 16
    s_add_u32 s47, s47, s49
    s_add_u32 s47, s47, 65536
    v_add_u32 v228, s47, v3
    v_add_u32 v229, s47, v6
    s_sub_u32 s48, s33, 1
    s_and_b32 s48, s48, 3
    s_lshl_b32 s48, s48, 1
    s_add_u32 s48, s48, s32
    s_and_b32 s47, s48, 3
    s_mul_i32 s47, s47, 6912
    s_lshr_b32 s49, s48, 2
    s_lshl_b32 s49, s49, 16
    s_add_u32 s47, s47, s49
    s_add_u32 s47, s47, 65536
    v_add_u32 v230, s47, v3
    v_add_u32 v231, s47, v6
    s_sub_u32 s48, s33, 2
    s_and_b32 s48, s48, 3
    s_lshl_b32 s48, s48, 1
    s_add_u32 s48, s48, s32
    s_and_b32 s47, s48, 3
    s_mul_i32 s47, s47, 6912
    s_lshr_b32 s49, s48, 2
    s_lshl_b32 s49, s49, 16
    s_add_u32 s47, s47, s49
    s_add_u32 s47, s47, 65536
    v_add_u32 v232, s47, v3
    v_add_u32 v233, s47, v6
    s_sub_u32 s48, s33, 3
    s_and_b32 s48, s48, 3
    s_lshl_b32 s48, s48, 1
    s_add_u32 s48, s48, s32
    s_and_b32 s47, s48, 3
    s_mul_i32 s47, s47, 6912
    s_lshr_b32 s49, s48, 2
    s_lshl_b32 s49, s49, 16
    s_add_u32 s47, s47, s49
    s_add_u32 s47, s47, 65536
    v_add_u32 v234, s47, v3
    v_add_u32 v235, s47, v6
    s_lshl_b32 s48, s34, 15
    s_lshl_b32 s49, s19, 10
    s_add_u32 s48, s48, s49
    s_add_u32 s48, s48, s3
    s_add_u32 s48, s48, 4194304
    s_cmp_lg_u32 s22, 0
    s_cbranch_scc1 L_fo_89
    v_lshrrev_b32 v167, 3, v1
    v_lshlrev_b32 v167, 15, v167
    v_and_b32 v166, 7, v1
    v_lshl_add_u32 v167, v166, 7, v167
    s_lshl_b32 s60, s18, 18
    s_lshl_b32 s61, s19, 10
    s_add_u32 s61, s61, s60
    s_add_u32 s61, s61, 4194304
    v_lshrrev_b32 v166, 5, v1
    v_and_b32 v165, 31, v1
    v_lshlrev_b32 v165, 7, v165
    v_lshl_add_u32 v165, v166, 15, v165
    s_and_b32 s62, s19, 3
    s_lshl_b32 s63, s62, 16
    s_add_u32 s63, s63, s60
    s_lshr_b32 s64, s19, 2
    s_lshl_b32 s65, s64, 12
    s_add_u32 s63, s63, s65
    s_add_u32 s63, s63, 2097152
    v_and_b32 v166, 7, v1
    v_lshlrev_b32 v166, 7, v166
    v_bfe_u32 v2, v1, 3, 1
    v_lshl_add_u32 v166, v2, 12, v166
    s_lshl_b32 s60, s18, 15
    s_lshl_b32 s62, s62, 13
    s_add_u32 s60, s60, s62
    s_lshr_b32 s64, s64, 1
    s_lshl_b32 s64, s64, 10
    s_add_u32 s60, s60, s64
    s_add_u32 s60, s60, 19136512
    s_cmp_eq_u32 s30, 1024
    s_cselect_b32 s61, s63, s61
    s_cselect_b64 vcc, -1, 0
    v_cndmask_b32 v167, v167, v165, vcc
    s_cmp_eq_u32 s30, 2048
    s_cselect_b32 s61, s60, s61
    s_cselect_b64 vcc, -1, 0
    v_cndmask_b32 v167, v167, v166, vcc
    s_lshr_b32 s62, s19, 1
    s_min_u32 s63, s62, 14
    s_mul_i32 s63, s63, 1536
    s_add_u32 s63, s63, 46399488
    s_lshl_b32 s62, s62, 9
    s_mul_i32 s64, s18, 24576
    s_add_u32 s62, s62, s64
    s_add_u32 s62, s62, 46137344
    v_and_b32 v165, 15, v1
    v_min_u32 v165, 11, v165
    v_lshlrev_b32 v165, 7, v165
    v_bfe_u32 v166, v1, 4, 1
    v_mul_u32_u24 v166, 24576, v166
    v_add3_u32 v165, v165, v166, s63
    v_and_b32 v166, 3, v1
    v_lshlrev_b32 v166, 7, v166
    v_bfe_u32 v2, v1, 2, 2
    v_min_u32 v2, 2, v2
    v_lshl_add_u32 v166, v2, 13, v166
    v_add_u32 v166, s62, v166
    v_cmp_gt_u32 vcc, 32, v1
    s_nop 1
    v_cndmask_b32 v165, v166, v165, vcc
    s_cmp_eq_u32 s16, 9
    s_cselect_b32 s61, 0, s61
    s_cselect_b64 vcc, -1, 0
    v_cndmask_b32 v167, v167, v165, vcc
    buffer_load_dword v165, v167, s[8:11], s61 offen
L_fo_89:
L_old_88:
    v_mfma_f32_32x32x16_bf16 v[72:87], v[28:31], v[12:15], 0
    v_exp_f32 v56, v56
    v_exp_f32 v57, v57
    v_exp_f32 v58, v58
    v_exp_f32 v59, v59
    v_exp_f32 v60, v60
    v_exp_f32 v61, v61
    v_mfma_f32_32x32x16_bf16 v[136:151], v[36:39], v[52:55], v[136:151]
    v_exp_f32 v62, v62
    v_exp_f32 v63, v63
    v_cvt_pk_bf16_f32 v48, v56, v57
    v_cvt_pk_bf16_f32 v49, v58, v59
    v_exp_f32 v64, v64
    v_cvt_pk_bf16_f32 v50, v60, v61
    v_exp_f32 v65, v65
    v_cvt_pk_bf16_f32 v51, v62, v63
    v_exp_f32 v66, v66
    v_exp_f32 v67, v67
    v_mfma_f32_32x32x16_bf16 v[88:103], v[40:43], v[48:51], v[88:103]
    v_exp_f32 v68, v68
    v_exp_f32 v69, v69
    v_cvt_pk_bf16_f32 v52, v64, v65
    v_exp_f32 v70, v70
    v_exp_f32 v71, v71
    v_cvt_pk_bf16_f32 v53, v66, v67
    v_cvt_pk_bf16_f32 v54, v68, v69
    v_cvt_pk_bf16_f32 v55, v70, v71
    v_mfma_f32_32x32x16_bf16 v[56:71], v[28:31], v[16:19], 0
    v_exp_f32 v72, v72
    v_exp_f32 v73, v73
    v_exp_f32 v74, v74
    v_exp_f32 v75, v75
    v_exp_f32 v76, v76
    v_exp_f32 v77, v77
    v_mfma_f32_32x32x16_bf16 v[88:103], v[44:47], v[52:55], v[88:103]
    v_exp_f32 v78, v78
    v_exp_f32 v79, v79
    v_cvt_pk_bf16_f32 v48, v72, v73
    v_cvt_pk_bf16_f32 v49, v74, v75
    v_exp_f32 v80, v80
    v_cvt_pk_bf16_f32 v50, v76, v77
    v_exp_f32 v81, v81
    v_cvt_pk_bf16_f32 v51, v78, v79
    v_exp_f32 v82, v82
    v_exp_f32 v83, v83
    v_mfma_f32_32x32x16_bf16 v[104:119], v[40:43], v[48:51], v[104:119]
    v_exp_f32 v84, v84
    v_exp_f32 v85, v85
    v_cvt_pk_bf16_f32 v52, v80, v81
    v_exp_f32 v86, v86
    v_exp_f32 v87, v87
    v_cvt_pk_bf16_f32 v53, v82, v83
    v_cvt_pk_bf16_f32 v54, v84, v85
    v_cvt_pk_bf16_f32 v55, v86, v87
    v_mfma_f32_32x32x16_bf16 v[72:87], v[28:31], v[20:23], 0
    v_exp_f32 v56, v56
    v_exp_f32 v57, v57
    v_exp_f32 v58, v58
    v_exp_f32 v59, v59
    v_exp_f32 v60, v60
    v_exp_f32 v61, v61
    v_mfma_f32_32x32x16_bf16 v[104:119], v[44:47], v[52:55], v[104:119]
    v_exp_f32 v62, v62
    v_exp_f32 v63, v63
    v_cvt_pk_bf16_f32 v48, v56, v57
    v_cvt_pk_bf16_f32 v49, v58, v59
    v_exp_f32 v64, v64
    v_cvt_pk_bf16_f32 v50, v60, v61
    v_exp_f32 v65, v65
    v_cvt_pk_bf16_f32 v51, v62, v63
    v_exp_f32 v66, v66
    v_exp_f32 v67, v67
    v_mfma_f32_32x32x16_bf16 v[120:135], v[40:43], v[48:51], v[120:135]
    s_nop 0
    ds_write_b128 v228, v[104:107] offset:0
    ds_write_b128 v228, v[108:111] offset:1024
    ds_write_b32 v229, v112 offset:2048
    v_exp_f32 v68, v68
    v_exp_f32 v69, v69
    v_cvt_pk_bf16_f32 v52, v64, v65
    v_exp_f32 v70, v70
    v_exp_f32 v71, v71
    v_cvt_pk_bf16_f32 v53, v66, v67
    v_cvt_pk_bf16_f32 v54, v68, v69
    v_cvt_pk_bf16_f32 v55, v70, v71
    v_exp_f32 v72, v72
    v_exp_f32 v73, v73
    v_exp_f32 v74, v74
    v_exp_f32 v75, v75
    v_exp_f32 v76, v76
    v_exp_f32 v77, v77
    v_mfma_f32_32x32x16_bf16 v[120:135], v[44:47], v[52:55], v[120:135]
    v_exp_f32 v78, v78
    v_exp_f32 v79, v79
    v_cvt_pk_bf16_f32 v48, v72, v73
    v_cvt_pk_bf16_f32 v49, v74, v75
    v_exp_f32 v80, v80
    v_cvt_pk_bf16_f32 v50, v76, v77
    v_exp_f32 v81, v81
    v_cvt_pk_bf16_f32 v51, v78, v79
    v_exp_f32 v82, v82
    v_exp_f32 v83, v83
    v_mfma_f32_32x32x16_bf16 v[136:151], v[40:43], v[48:51], v[136:151]
    s_nop 0
    ds_write_b128 v228, v[120:123] offset:2304
    ds_write_b128 v228, v[124:127] offset:3328
    ds_write_b32 v229, v128 offset:4352
    v_exp_f32 v84, v84
    v_exp_f32 v85, v85
    v_cvt_pk_bf16_f32 v52, v80, v81
    v_exp_f32 v86, v86
    v_exp_f32 v87, v87
    v_cvt_pk_bf16_f32 v53, v82, v83
    v_cvt_pk_bf16_f32 v54, v84, v85
    v_cvt_pk_bf16_f32 v55, v86, v87
    s_setprio 0
    s_nop 0
    v_mfma_f32_32x32x16_bf16 v[136:151], v[44:47], v[52:55], v[136:151]
    s_nop 11
    ds_write_b128 v228, v[136:139] offset:4608
    ds_write_b128 v228, v[140:143] offset:5632
    ds_write_b32 v229, v144 offset:6656
    s_waitcnt vmcnt(0) lgkmcnt(0)
    s_barrier
    ds_read_b128 v[104:107], v230 offset:0
    ds_read_b128 v[108:111], v230 offset:1024
    ds_read_b32 v112, v231 offset:2048
    ds_read_b128 v[120:123], v232 offset:2304
    ds_read_b128 v[124:127], v232 offset:3328
    ds_read_b32 v128, v233 offset:4352
    ds_read_b128 v[136:139], v234 offset:4608
    ds_read_b128 v[140:143], v234 offset:5632
    ds_read_b32 v144, v235 offset:6656
    s_waitcnt lgkmcnt(6)
    v_pk_add_f32 v[88:89], v[88:89], v[104:105]
    v_pk_add_f32 v[90:91], v[90:91], v[106:107]
    v_pk_add_f32 v[92:93], v[92:93], v[108:109]
    v_pk_add_f32 v[94:95], v[94:95], v[110:111]
    v_add_f32 v96, v96, v112
    s_waitcnt lgkmcnt(3)
    v_pk_add_f32 v[88:89], v[88:89], v[120:121]
    v_pk_add_f32 v[90:91], v[90:91], v[122:123]
    v_pk_add_f32 v[92:93], v[92:93], v[124:125]
    v_pk_add_f32 v[94:95], v[94:95], v[126:127]
    v_add_f32 v96, v96, v128
    s_waitcnt lgkmcnt(0)
    v_pk_add_f32 v[88:89], v[88:89], v[136:137]
    v_pk_add_f32 v[90:91], v[90:91], v[138:139]
    v_pk_add_f32 v[92:93], v[92:93], v[140:141]
    v_pk_add_f32 v[94:95], v[94:95], v[142:143]
    v_add_f32 v96, v96, v144
    v_rcp_f32 v157, v96
    s_nop 0
    v_mul_f32 v72, v88, v157
    v_mul_f32 v73, v89, v157
    v_mul_f32 v74, v90, v157
    v_mul_f32 v75, v91, v157
    v_mul_f32 v76, v92, v157
    v_mul_f32 v77, v93, v157
    v_mul_f32 v78, v94, v157
    v_mul_f32 v79, v95, v157
    v_cvt_pk_bf16_f32 v80, v72, v73
    v_cvt_pk_bf16_f32 v81, v74, v75
    v_cvt_pk_bf16_f32 v82, v76, v77
    v_cvt_pk_bf16_f32 v83, v78, v79
    s_cmp_lg_u32 s22, 0
    s_cbranch_scc1 L_sts_90
    buffer_store_dwordx4 v[80:83], v3, s[8:11], s48 offen
L_std_91:
    v_max3_f32 v152, abs(v88), abs(v89), abs(v90)
    v_max3_f32 v152, v152, abs(v91), abs(v92)
    v_max3_f32 v152, v152, abs(v93), abs(v94)
    v_add_f32 v153, v88, v89
    v_add_f32 v154, v90, v91
    v_add_f32 v155, v92, v93
    v_add_f32 v156, v94, v95
    v_max_f32 v152, v152, abs(v95)
    v_add_f32 v153, v153, v154
    v_add_f32 v155, v155, v156
    v_add_f32 v153, v153, v155
    s_mov_b32 s50, 0x17800000
    s_mov_b32 s51, 0x67800000
    s_mov_b32 s52, 0x7b800000
    v_cmp_le_f32 s[54:55], s50, v96
    v_cmp_ge_f32 s[56:57], s51, v96
    v_cmp_ge_f32 s[58:59], s52, v152
    v_cmp_o_f32 vcc, v153, v153
    s_nop 3
    s_and_b64 s[54:55], s[54:55], s[56:57]
    s_and_b64 s[58:59], s[58:59], vcc
    s_and_b64 s[54:55], s[54:55], s[58:59]
    s_cmp_eq_u64 s[54:55], -1
    s_cbranch_scc1 L_afin_92
    v_mov_b32 v152, 0xff800000
    s_mov_b32 s46, 0
    s_mov_b32 s47, s35
L_amx_93:
    buffer_load_dwordx4 v[24:27], v3, s[8:11], s47 offen sc1
    s_waitcnt vmcnt(0)
    v_mfma_f32_32x32x16_bf16 v[56:71], v[24:27], v[8:11], 0
    s_nop 15
    v_max3_f32 v152, v152, v56, v57
    v_max3_f32 v152, v152, v58, v59
    v_max3_f32 v152, v152, v60, v61
    v_max3_f32 v152, v152, v62, v63
    v_max3_f32 v152, v152, v64, v65
    v_max3_f32 v152, v152, v66, v67
    v_max3_f32 v152, v152, v68, v69
    v_max3_f32 v152, v152, v70, v71
    s_add_u32 s47, s47, 2048
    s_add_u32 s46, s46, 1
    s_cmp_lt_u32 s46, 64
    s_cbranch_scc1 L_amx_93
    v_mov_b32 v153, v152
    s_nop 1
    v_permlane32_swap_b32 v152, v153
    s_nop 1
    v_max_f32 v152, v152, v153
    s_mov_b32 s46, 0
    s_mov_b32 s47, s35
    v_sub_f32 v172, 0, v152
    v_mov_b32 v88, 0
    v_sub_f32 v173, 0, v152
    v_mov_b32 v89, 0
    v_sub_f32 v174, 0, v152
    v_mov_b32 v90, 0
    v_sub_f32 v175, 0, v152
    v_mov_b32 v91, 0
    v_sub_f32 v176, 0, v152
    v_mov_b32 v92, 0
    v_sub_f32 v177, 0, v152
    v_mov_b32 v93, 0
    v_sub_f32 v178, 0, v152
    v_mov_b32 v94, 0
    v_sub_f32 v179, 0, v152
    v_mov_b32 v95, 0
    v_sub_f32 v180, 0, v152
    v_mov_b32 v96, 0
    v_sub_f32 v181, 0, v152
    v_mov_b32 v97, 0
    v_sub_f32 v182, 0, v152
    v_mov_b32 v98, 0
    v_sub_f32 v183, 0, v152
    v_mov_b32 v99, 0
    v_sub_f32 v184, 0, v152
    v_mov_b32 v100, 0
    v_sub_f32 v185, 0, v152
    v_mov_b32 v101, 0
    v_sub_f32 v186, 0, v152
    v_mov_b32 v102, 0
    v_sub_f32 v187, 0, v152
    v_mov_b32 v103, 0
L_are_94:
    buffer_load_dwordx4 v[24:27], v3, s[8:11], s47 offen sc1
    s_mov_b64 exec, s[44:45]
    buffer_load_dwordx4 v[32:35], v159, s[8:11], s47 offen sc1
    buffer_load_dwordx4 v[36:39], v159, s[8:11], s47 offen offset:512 sc1
    s_mov_b64 exec, -1
    s_waitcnt vmcnt(0)
    v_mfma_f32_32x32x16_bf16 v[56:71], v[24:27], v[8:11], v[172:187]
    s_nop 15
    v_exp_f32 v56, v56
    v_exp_f32 v57, v57
    v_exp_f32 v58, v58
    v_exp_f32 v59, v59
    v_exp_f32 v60, v60
    v_exp_f32 v61, v61
    v_exp_f32 v62, v62
    v_exp_f32 v63, v63
    v_exp_f32 v64, v64
    v_exp_f32 v65, v65
    v_exp_f32 v66, v66
    v_exp_f32 v67, v67
    v_exp_f32 v68, v68
    v_exp_f32 v69, v69
    v_exp_f32 v70, v70
    v_exp_f32 v71, v71
    s_nop 0
    v_cvt_pk_bf16_f32 v48, v56, v57
    v_cvt_pk_bf16_f32 v49, v58, v59
    v_cvt_pk_bf16_f32 v50, v60, v61
    v_cvt_pk_bf16_f32 v51, v62, v63
    v_cvt_pk_bf16_f32 v52, v64, v65
    v_cvt_pk_bf16_f32 v53, v66, v67
    v_cvt_pk_bf16_f32 v54, v68, v69
    v_cvt_pk_bf16_f32 v55, v70, v71
    s_nop 1
    v_mfma_f32_32x32x16_bf16 v[88:103], v[32:35], v[48:51], v[88:103]
    v_mfma_f32_32x32x16_bf16 v[88:103], v[36:39], v[52:55], v[88:103]
    s_add_u32 s47, s47, 2048
    s_add_u32 s46, s46, 1
    s_cmp_lt_u32 s46, 64
    s_cbranch_scc1 L_are_94
    s_nop 15
    v_rcp_f32 v157, v96
    s_nop 0
    v_mul_f32 v72, v88, v157
    v_mul_f32 v73, v89, v157
    v_mul_f32 v74, v90, v157
    v_mul_f32 v75, v91, v157
    v_mul_f32 v76, v92, v157
    v_mul_f32 v77, v93, v157
    v_mul_f32 v78, v94, v157
    v_mul_f32 v79, v95, v157
    v_cvt_pk_bf16_f32 v80, v72, v73
    v_cvt_pk_bf16_f32 v81, v74, v75
    v_cvt_pk_bf16_f32 v82, v76, v77
    v_cvt_pk_bf16_f32 v83, v78, v79
    s_cmp_lg_u32 s22, 0
    s_cbranch_scc1 L_sts_95
    buffer_store_dwordx4 v[80:83], v3, s[8:11], s48 offen
L_std_96:
    s_waitcnt vmcnt(0)
L_afin_92:
    s_add_u32 s61, s25, 2
    s_lshr_b32 s62, s17, 8
    v_mov_b32 v2, s61
    s_add_u32 s62, s62, s21
    s_mov_b64 exec, 1
    s_waitcnt vmcnt(0)
    s_cmp_lg_u32 s22, 0
    s_cbranch_scc1 L_sts_97
    buffer_store_dword v2, v7, s[8:11], s62 offen
L_std_98:
    s_mov_b64 exec, -1
    s_cmp_ge_u32 s16, 4
    s_cbranch_scc1 L_ld_99
    s_branch L_se_100
L_ld_99:
    s_mul_i32 s64, s30, 6
    s_add_u32 s65, s64, s28
    s_add_u32 m0, s64, 94208
    s_add_u32 s66, s65, 0
    buffer_load_dwordx4 v3, s[8:11], s66 offen offset:0 lds
    buffer_load_dwordx4 v3, s[8:11], s66 offen offset:1024 lds
    buffer_load_dwordx4 v3, s[8:11], s66 offen offset:2048 lds
    buffer_load_dwordx4 v3, s[8:11], s66 offen offset:3072 lds
    s_add_u32 m0, s64, 98304
    s_add_u32 s66, s65, 4096
    buffer_load_dwordx4 v3, s[8:11], s66 offen offset:0 lds
    buffer_load_dwordx4 v3, s[8:11], s66 offen offset:1024 lds
L_se_100:
L_wo_start:
    s_cmp_ge_u32 s16, 4
    s_cbranch_scc1 L_ld_101
    s_and_b32 s39, s16, 1
    s_lshr_b32 s35, s16, 1
    s_lshl_b32 s32, s18, 3
    s_and_b32 s33, s19, 3
    s_lshl_b32 s33, s33, 1
    s_add_u32 s32, s32, s33
    s_add_u32 s32, s32, s39
    s_lshr_b32 s33, s19, 2
    s_mul_i32 s34, s32, 32768
    s_mul_i32 s40, s35, 16384
    s_add_u32 s34, s34, s40
    s_add_u32 s34, s34, s3
    s_add_u32 s34, s34, 4194304
    s_lshl_b32 s36, s33, 1
    s_add_u32 s36, s36, s35
    s_lshl_b32 s37, s32, 15
    s_lshl_b32 s40, s36, 11
    s_add_u32 s37, s37, s40
    s_mul_i32 s40, s35, 3072
    s_lshl_b32 s41, s35, 10
    s_add_u32 s41, s41, 1024
    v_add_u32 v92, s40, v3
    v_add_u32 v93, s40, v4
    v_add_u32 v94, s40, v5
    v_add_u32 v95, s41, v3
    v_add_u32 v96, s41, v4
    v_add_u32 v97, s41, v5
    s_lshl_b32 s42, s16, 12
    s_xor_b32 s43, s42, 0x2000
    s_add_u32 s42, s42, 143360
    s_add_u32 s43, s43, 143360
    v_add_u32 v84, s42, v3
    v_add_u32 v85, s43, v3
    s_lshl_b32 s44, s32, 12
    s_lshr_b32 s45, s36, 2
    s_lshl_b32 s45, s45, 10
    s_add_u32 s44, s44, s45
    s_and_b32 s45, s36, 3
    s_lshl_b32 s45, s45, 2
    s_add_u32 s44, s44, s45
    s_add_u32 s44, s44, s3
    s_add_u32 s44, s44, 19136512
    s_add_u32 s37, s37, s3
    s_add_u32 s37, s37, 2097152
    v_lshlrev_b32 v28, 16, v236
    v_and_b32 v29, 0xffff0000, v236
    v_lshlrev_b32 v30, 16, v237
    v_and_b32 v31, 0xffff0000, v237
    v_lshlrev_b32 v32, 16, v238
    v_and_b32 v33, 0xffff0000, v238
    v_lshlrev_b32 v34, 16, v239
    v_and_b32 v35, 0xffff0000, v239
    v_lshlrev_b32 v36, 16, v240
    v_and_b32 v37, 0xffff0000, v240
    v_lshlrev_b32 v38, 16, v241
    v_and_b32 v39, 0xffff0000, v241
    v_lshlrev_b32 v40, 16, v242
    v_and_b32 v41, 0xffff0000, v242
    v_lshlrev_b32 v42, 16, v243
    v_and_b32 v43, 0xffff0000, v243
    s_barrier
    buffer_load_dwordx4 v[100:103], v3, s[8:11], s34 offen offset:0 sc1
    buffer_load_dwordx4 v[104:107], v3, s[8:11], s34 offen offset:1024 sc1
    buffer_load_dwordx4 v[108:111], v3, s[8:11], s34 offen offset:2048 sc1
    buffer_load_dwordx4 v[112:115], v3, s[8:11], s34 offen offset:3072 sc1
    s_add_u32 s34, s34, 4096
    buffer_load_dwordx4 v[116:119], v3, s[8:11], s34 offen offset:0 sc1
    buffer_load_dwordx4 v[120:123], v3, s[8:11], s34 offen offset:1024 sc1
    buffer_load_dwordx4 v[124:127], v3, s[8:11], s34 offen offset:2048 sc1
    buffer_load_dwordx4 v[128:131], v3, s[8:11], s34 offen offset:3072 sc1
    s_add_u32 s34, s34, 4096
    buffer_load_dwordx4 v[132:135], v3, s[8:11], s34 offen offset:0 sc1
    buffer_load_dwordx4 v[136:139], v3, s[8:11], s34 offen offset:1024 sc1
    buffer_load_dwordx4 v[140:143], v3, s[8:11], s34 offen offset:2048 sc1
    buffer_load_dwordx4 v[144:147], v3, s[8:11], s34 offen offset:3072 sc1
    s_add_u32 s34, s34, 4096
    ds_read_b128 v[44:47], v95 offset:0
    ds_read_b128 v[48:51], v92 offset:0
    ds_read_b128 v[52:55], v95 offset:4096
    ds_read_b128 v[56:59], v92 offset:4096
    ds_read_b128 v[60:63], v95 offset:8192
    ds_read_b128 v[64:67], v92 offset:8192
    s_waitcnt vmcnt(10)
    s_waitcnt lgkmcnt(4)
    v_mfma_f32_32x32x16_bf16 v[12:27], v[44:47], v[100:103], 0
    ds_read_b128 v[44:47], v95 offset:12288
    buffer_load_dwordx4 v[148:151], v3, s[8:11], s34 offen offset:0 sc1
    v_mfma_f32_32x32x16_bf16 v[28:43], v[48:51], v[100:103], v[28:43]
    ds_read_b128 v[48:51], v92 offset:12288
    s_waitcnt lgkmcnt(4)
    v_mfma_f32_32x32x16_bf16 v[12:27], v[52:55], v[104:107], v[12:27]
    ds_read_b128 v[52:55], v95 offset:16384
    buffer_load_dwordx4 v[152:155], v3, s[8:11], s34 offen offset:1024 sc1
    v_mfma_f32_32x32x16_bf16 v[28:43], v[56:59], v[104:107], v[28:43]
    ds_read_b128 v[56:59], v92 offset:16384
    s_waitcnt vmcnt(10)
    s_waitcnt lgkmcnt(4)
    v_mfma_f32_32x32x16_bf16 v[12:27], v[60:63], v[108:111], v[12:27]
    ds_read_b128 v[60:63], v95 offset:20480
    buffer_load_dwordx4 v[156:159], v3, s[8:11], s34 offen offset:2048 sc1
    v_mfma_f32_32x32x16_bf16 v[28:43], v[64:67], v[108:111], v[28:43]
    ds_read_b128 v[64:67], v92 offset:20480
    s_waitcnt lgkmcnt(4)
    v_mfma_f32_32x32x16_bf16 v[12:27], v[44:47], v[112:115], v[12:27]
    ds_read_b128 v[44:47], v95 offset:24576
    buffer_load_dwordx4 v[160:163], v3, s[8:11], s34 offen offset:3072 sc1
    s_add_u32 s34, s34, 4096
    v_mfma_f32_32x32x16_bf16 v[28:43], v[48:51], v[112:115], v[28:43]
    ds_read_b128 v[48:51], v92 offset:24576
    s_waitcnt vmcnt(10)
    s_waitcnt lgkmcnt(4)
    v_mfma_f32_32x32x16_bf16 v[12:27], v[52:55], v[116:119], v[12:27]
    ds_read_b128 v[52:55], v95 offset:28672
    v_mfma_f32_32x32x16_bf16 v[28:43], v[56:59], v[116:119], v[28:43]
    ds_read_b128 v[56:59], v92 offset:28672
    s_waitcnt lgkmcnt(4)
    v_mfma_f32_32x32x16_bf16 v[12:27], v[60:63], v[120:123], v[12:27]
    ds_read_b128 v[60:63], v95 offset:32768
    v_mfma_f32_32x32x16_bf16 v[28:43], v[64:67], v[120:123], v[28:43]
    ds_read_b128 v[64:67], v92 offset:32768
    s_waitcnt vmcnt(8)
    s_waitcnt lgkmcnt(4)
    v_mfma_f32_32x32x16_bf16 v[12:27], v[44:47], v[124:127], v[12:27]
    ds_read_b128 v[44:47], v95 offset:36864
    v_mfma_f32_32x32x16_bf16 v[28:43], v[48:51], v[124:127], v[28:43]
    ds_read_b128 v[48:51], v92 offset:36864
    s_waitcnt lgkmcnt(4)
    v_mfma_f32_32x32x16_bf16 v[12:27], v[52:55], v[128:131], v[12:27]
    ds_read_b128 v[52:55], v95 offset:40960
    v_mfma_f32_32x32x16_bf16 v[28:43], v[56:59], v[128:131], v[28:43]
    ds_read_b128 v[56:59], v92 offset:40960
    s_waitcnt vmcnt(6)
    s_waitcnt lgkmcnt(4)
    v_mfma_f32_32x32x16_bf16 v[12:27], v[60:63], v[132:135], v[12:27]
    ds_read_b128 v[60:63], v95 offset:45056
    v_mfma_f32_32x32x16_bf16 v[28:43], v[64:67], v[132:135], v[28:43]
    ds_read_b128 v[64:67], v92 offset:45056
    s_waitcnt lgkmcnt(4)
    v_mfma_f32_32x32x16_bf16 v[12:27], v[44:47], v[136:139], v[12:27]
    ds_read_b128 v[44:47], v95 offset:49152
    v_mfma_f32_32x32x16_bf16 v[28:43], v[48:51], v[136:139], v[28:43]
    ds_read_b128 v[48:51], v92 offset:49152
    s_waitcnt vmcnt(4)
    s_waitcnt lgkmcnt(4)
    v_mfma_f32_32x32x16_bf16 v[12:27], v[52:55], v[140:143], v[12:27]
    ds_read_b128 v[52:55], v95 offset:53248
    v_mfma_f32_32x32x16_bf16 v[28:43], v[56:59], v[140:143], v[28:43]
    ds_read_b128 v[56:59], v92 offset:53248
    s_waitcnt lgkmcnt(4)
    v_mfma_f32_32x32x16_bf16 v[12:27], v[60:63], v[144:147], v[12:27]
    ds_read_b128 v[60:63], v95 offset:57344
    v_mfma_f32_32x32x16_bf16 v[28:43], v[64:67], v[144:147], v[28:43]
    ds_read_b128 v[64:67], v92 offset:57344
    s_waitcnt vmcnt(2)
    s_waitcnt lgkmcnt(4)
    v_mfma_f32_32x32x16_bf16 v[12:27], v[44:47], v[148:151], v[12:27]
    ds_read_b128 v[44:47], v95 offset:61440
    v_mfma_f32_32x32x16_bf16 v[28:43], v[48:51], v[148:151], v[28:43]
    ds_read_b128 v[48:51], v92 offset:61440
    s_waitcnt lgkmcnt(4)
    v_mfma_f32_32x32x16_bf16 v[12:27], v[52:55], v[152:155], v[12:27]
    v_mfma_f32_32x32x16_bf16 v[28:43], v[56:59], v[152:155], v[28:43]
    s_waitcnt vmcnt(0)
    s_waitcnt lgkmcnt(2)
    v_mfma_f32_32x32x16_bf16 v[12:27], v[60:63], v[156:159], v[12:27]
    v_mfma_f32_32x32x16_bf16 v[28:43], v[64:67], v[156:159], v[28:43]
    s_waitcnt lgkmcnt(0)
    v_mfma_f32_32x32x16_bf16 v[12:27], v[44:47], v[160:163], v[12:27]
    v_mfma_f32_32x32x16_bf16 v[28:43], v[48:51], v[160:163], v[28:43]
    s_nop 10
    ds_write_b128 v84, v[12:15] offset:0
    ds_write_b128 v84, v[16:19] offset:1024
    ds_write_b128 v84, v[20:23] offset:2048
    ds_write_b128 v84, v[24:27] offset:3072
    s_waitcnt lgkmcnt(0)
    s_barrier
    ds_read_b128 v[12:15], v85 offset:0
    ds_read_b128 v[16:19], v85 offset:1024
    ds_read_b128 v[20:23], v85 offset:2048
    ds_read_b128 v[24:27], v85 offset:3072
    s_waitcnt lgkmcnt(3)
    v_pk_add_f32 v[28:29], v[28:29], v[12:13]
    v_pk_add_f32 v[30:31], v[30:31], v[14:15]
    v_cvt_pk_bf16_f32 v236, v28, v29
    v_cvt_pk_bf16_f32 v237, v30, v31
    s_waitcnt lgkmcnt(2)
    v_pk_add_f32 v[32:33], v[32:33], v[16:17]
    v_pk_add_f32 v[34:35], v[34:35], v[18:19]
    v_cvt_pk_bf16_f32 v238, v32, v33
    v_cvt_pk_bf16_f32 v239, v34, v35
    s_waitcnt lgkmcnt(1)
    v_pk_add_f32 v[36:37], v[36:37], v[20:21]
    v_pk_add_f32 v[38:39], v[38:39], v[22:23]
    v_cvt_pk_bf16_f32 v240, v36, v37
    v_cvt_pk_bf16_f32 v241, v38, v39
    s_waitcnt lgkmcnt(0)
    v_pk_add_f32 v[40:41], v[40:41], v[24:25]
    v_pk_add_f32 v[42:43], v[42:43], v[26:27]
    v_cvt_pk_bf16_f32 v242, v40, v41
    v_cvt_pk_bf16_f32 v243, v42, v43
    s_cmp_lg_u32 s22, 0
    s_cbranch_scc1 L_sts_105
    buffer_store_dwordx4 v[236:239], v3, s[8:11], s37 offen
    buffer_store_dwordx4 v[240:243], v3, s[8:11], s37 offen offset:1024
L_std_106:
    v_pk_add_f32 v[86:87], v[28:29], v[30:31]
    v_pk_mul_f32 v[88:89], v[28:29], v[28:29]
    v_pk_fma_f32 v[88:89], v[30:31], v[30:31], v[88:89]
    v_pk_add_f32 v[86:87], v[86:87], v[32:33]
    v_pk_fma_f32 v[88:89], v[32:33], v[32:33], v[88:89]
    v_pk_add_f32 v[86:87], v[86:87], v[34:35]
    v_pk_fma_f32 v[88:89], v[34:35], v[34:35], v[88:89]
    v_pk_add_f32 v[86:87], v[86:87], v[36:37]
    v_pk_fma_f32 v[88:89], v[36:37], v[36:37], v[88:89]
    v_pk_add_f32 v[86:87], v[86:87], v[38:39]
    v_pk_fma_f32 v[88:89], v[38:39], v[38:39], v[88:89]
    v_pk_add_f32 v[86:87], v[86:87], v[40:41]
    v_pk_fma_f32 v[88:89], v[40:41], v[40:41], v[88:89]
    v_pk_add_f32 v[86:87], v[86:87], v[42:43]
    v_pk_fma_f32 v[88:89], v[42:43], v[42:43], v[88:89]
    v_add_f32 v86, v86, v87
    v_add_f32 v88, v88, v89
    s_nop 1
    v_permlane32_swap_b32 v86, v88
    s_nop 1
    v_add_f32 v86, v86, v88
    s_cmp_lg_u32 s22, 0
    s_cbranch_scc1 L_sts_107
    buffer_store_dword v86, v3, s[8:11], s44 offen
L_std_108:
    s_barrier
    s_add_u32 s61, s25, 3
    v_mov_b32 v2, s61
    s_mov_b64 exec, 1
    s_waitcnt vmcnt(0)
    s_cmp_lg_u32 s22, 0
    s_cbranch_scc1 L_sts_109
    buffer_store_dword v2, v253, s[8:11], s21 offen
L_std_110:
    s_mov_b64 exec, -1
    s_branch L_se_102
L_ld_101:
    s_cmp_lg_u32 s16, 7
    s_cbranch_scc1 L_w0_111
    s_add_u32 s62, s25, 2
    s_mov_b32 exec_lo, -1
    s_mov_b32 exec_hi, 0
    s_mov_b32 s60, 0
    buffer_load_dwordx4 v[244:247], v254, s[8:11], s31 offen sc1
    buffer_load_dwordx4 v[248:251], v254, s[8:11], s31 offen offset:16 sc1
L_poll_112:
    buffer_load_dwordx4 v[224:227], v254, s[8:11], s31 offen sc1
    buffer_load_dwordx4 v[228:231], v254, s[8:11], s31 offen offset:16 sc1
    s_waitcnt vmcnt(2)
    v_min3_u32 v244, v244, v245, v246
    v_min3_u32 v247, v247, v248, v249
    v_min3_u32 v244, v244, v250, v251
    v_min_u32 v244, v244, v247
    v_cmp_gt_u32 vcc, s62, v244
    s_add_u32 s60, s60, 1
    s_cmp_gt_u32 s60, 0x4000
    s_cbranch_vccz L_polld_113
    buffer_load_dwordx4 v[244:247], v254, s[8:11], s31 offen sc1
    buffer_load_dwordx4 v[248:251], v254, s[8:11], s31 offen offset:16 sc1
    s_waitcnt vmcnt(2)
    v_min3_u32 v224, v224, v225, v226
    v_min3_u32 v227, v227, v228, v229
    v_min3_u32 v224, v224, v230, v231
    v_min_u32 v224, v224, v227
    v_cmp_gt_u32 vcc, s62, v224
    s_cbranch_scc1 L_polld_113
    s_nop 0
    s_cbranch_vccnz L_poll_112
L_polld_113:
    s_mov_b64 exec, -1
L_w0_111:
    s_setprio 0
    s_barrier
    s_mul_i32 s64, s30, 6
    s_add_u32 s65, s64, s28
    s_add_u32 m0, s64, 118784
    s_add_u32 s66, s65, 24576
    buffer_load_dwordx4 v3, s[8:11], s66 offen offset:0 lds
    buffer_load_dwordx4 v3, s[8:11], s66 offen offset:1024 lds
    buffer_load_dwordx4 v3, s[8:11], s66 offen offset:2048 lds
    buffer_load_dwordx4 v3, s[8:11], s66 offen offset:3072 lds
    s_add_u32 m0, s64, 122880
    s_add_u32 s66, s65, 28672
    buffer_load_dwordx4 v3, s[8:11], s66 offen offset:0 lds
    buffer_load_dwordx4 v3, s[8:11], s66 offen offset:1024 lds
    s_mul_i32 s64, s30, 6
    s_add_u32 s65, s64, s28
    s_add_u32 m0, s64, 69632
    s_add_u32 s66, s65, 49152
    buffer_load_dwordx4 v3, s[8:11], s66 offen offset:0 lds
    buffer_load_dwordx4 v3, s[8:11], s66 offen offset:1024 lds
    buffer_load_dwordx4 v3, s[8:11], s66 offen offset:2048 lds
    buffer_load_dwordx4 v3, s[8:11], s66 offen offset:3072 lds
    s_add_u32 m0, s64, 73728
    s_add_u32 s66, s65, 53248
    buffer_load_dwordx4 v3, s[8:11], s66 offen offset:0 lds
    buffer_load_dwordx4 v3, s[8:11], s66 offen offset:1024 lds
    s_barrier
    s_barrier
    s_mul_i32 s64, s30, 6
    s_add_u32 s65, s64, s28
    s_add_u32 m0, s64, 0
    s_add_u32 s66, s65, 73728
    buffer_load_dwordx4 v3, s[8:11], s66 offen offset:0 lds
    buffer_load_dwordx4 v3, s[8:11], s66 offen offset:1024 lds
    buffer_load_dwordx4 v3, s[8:11], s66 offen offset:2048 lds
    buffer_load_dwordx4 v3, s[8:11], s66 offen offset:3072 lds
    s_add_u32 m0, s64, 4096
    s_add_u32 s66, s65, 77824
    buffer_load_dwordx4 v3, s[8:11], s66 offen offset:0 lds
    buffer_load_dwordx4 v3, s[8:11], s66 offen offset:1024 lds
    s_mul_i32 s64, s30, 6
    s_add_u32 s65, s64, s28
    s_add_u32 m0, s64, 24576
    s_add_u32 s66, s65, 98304
    buffer_load_dwordx4 v3, s[8:11], s66 offen offset:0 lds
    buffer_load_dwordx4 v3, s[8:11], s66 offen offset:1024 lds
    buffer_load_dwordx4 v3, s[8:11], s66 offen offset:2048 lds
    buffer_load_dwordx4 v3, s[8:11], s66 offen offset:3072 lds
    s_add_u32 m0, s64, 28672
    s_add_u32 s66, s65, 102400
    buffer_load_dwordx4 v3, s[8:11], s66 offen offset:0 lds
    buffer_load_dwordx4 v3, s[8:11], s66 offen offset:1024 lds
L_se_102:
    s_cmp_ge_u32 s16, 4
    s_cbranch_scc1 L_ld_114
    s_lshl_b32 s32, s18, 3
    s_and_b32 s33, s19, 1
    s_lshl_b32 s33, s33, 2
    s_add_u32 s32, s32, s33
    s_add_u32 s32, s32, s16
    s_lshr_b32 s33, s19, 1
    s_lshl_b32 s34, s32, 15
    s_add_u32 s34, s34, s3
    s_add_u32 s34, s34, 2097152
    s_lshl_b32 s35, s32, 12
    s_add_u32 s35, s35, s3
    s_add_u32 s35, s35, 19136512
    s_min_u32 s38, s33, 14
    s_mul_i32 s36, s38, 1536
    s_add_u32 s37, s36, 46424064
    s_add_u32 s36, s36, 46399488
    s_mul_i32 s38, s32, 88064
    s_mul_i32 s39, s33, 6144
    s_add_u32 s38, s38, s39
    s_add_u32 s38, s38, s3
    s_add_u32 s38, s38, 12582912
    v_and_b32 v177, 31, v1
    v_lshlrev_b32 v177, 2, v177
    v_lshrrev_b32 v169, 5, v1
    v_lshl_add_u32 v177, v169, 8, v177
    s_mov_b32 s59, 0x05040100
    v_mov_b32 v147, 0
    v_mov_b32 v151, 0
    v_mov_b32 v155, 0
    v_mov_b32 v159, 0
    v_mov_b32 v163, 0
    v_mov_b32 v167, 0
    s_cmp_ge_u32 s19, 30
    s_cbranch_scc1 L_gidle_116
    s_barrier
    buffer_load_dwordx4 v[184:187], v3, s[8:11], s34 offen offset:0 sc1
    buffer_load_dwordx4 v[188:191], v3, s[8:11], s34 offen offset:1024 sc1
    buffer_load_dwordx4 v[192:195], v3, s[8:11], s34 offen offset:2048 sc1
    ds_read_b128 v[104:107], v4 offset:28672
    ds_read_b128 v[108:111], v4 offset:29696
    ds_read_b128 v[112:115], v4 offset:30720
    ds_read_b128 v[116:119], v4 offset:31744
    ds_read_b128 v[120:123], v4 offset:32768
    ds_read_b128 v[124:127], v4 offset:33792
    s_waitcnt vmcnt(1)
    s_waitcnt lgkmcnt(4)
    v_mfma_f32_32x32x16_bf16 v[8:23], v[104:107], v[184:187], 0
    ds_read_b128 v[104:107], v4 offset:34816
    buffer_load_dwordx4 v[128:131], v3, s[8:11], s35 offen offset:0 sc1
    v_mfma_f32_32x32x16_bf16 v[24:39], v[108:111], v[184:187], 0
    ds_read_b128 v[108:111], v4 offset:35840
    buffer_load_dwordx4 v[196:199], v3, s[8:11], s34 offen offset:3072 sc1
    s_add_u32 s34, s34, 4096
    s_waitcnt lgkmcnt(4)
    v_mfma_f32_32x32x16_bf16 v[40:55], v[112:115], v[184:187], 0
    ds_read_b128 v[112:115], v4 offset:36864
    v_mfma_f32_32x32x16_bf16 v[56:71], v[116:119], v[184:187], 0
    ds_read_b128 v[116:119], v4 offset:37888
    buffer_load_dwordx4 v[132:135], v3, s[8:11], s35 offen offset:1024 sc1
    s_waitcnt lgkmcnt(4)
    v_mfma_f32_32x32x16_bf16 v[72:87], v[120:123], v[184:187], 0
    ds_read_b128 v[120:123], v4 offset:38912
    buffer_load_dwordx4 v[200:203], v3, s[8:11], s34 offen offset:0 sc1
    v_mfma_f32_32x32x16_bf16 v[88:103], v[124:127], v[184:187], 0
    ds_read_b128 v[124:127], v4 offset:39936
    s_waitcnt lgkmcnt(4)
    v_mfma_f32_32x32x16_bf16 v[8:23], v[104:107], v[188:191], v[8:23]
    ds_read_b128 v[104:107], v4 offset:40960
    buffer_load_dwordx4 v[136:139], v3, s[8:11], s35 offen offset:2048 sc1
    v_mfma_f32_32x32x16_bf16 v[24:39], v[108:111], v[188:191], v[24:39]
    ds_read_b128 v[108:111], v4 offset:41984
    buffer_load_dwordx4 v[204:207], v3, s[8:11], s34 offen offset:1024 sc1
    s_waitcnt lgkmcnt(4)
    v_mfma_f32_32x32x16_bf16 v[40:55], v[112:115], v[188:191], v[40:55]
    ds_read_b128 v[112:115], v4 offset:43008
    v_mfma_f32_32x32x16_bf16 v[56:71], v[116:119], v[188:191], v[56:71]
    ds_read_b128 v[116:119], v4 offset:44032
    buffer_load_dwordx4 v[140:143], v3, s[8:11], s35 offen offset:3072 sc1
    s_waitcnt lgkmcnt(4)
    v_mfma_f32_32x32x16_bf16 v[72:87], v[120:123], v[188:191], v[72:87]
    ds_read_b128 v[120:123], v4 offset:45056
    buffer_load_dwordx4 v[208:211], v3, s[8:11], s34 offen offset:2048 sc1
    v_mfma_f32_32x32x16_bf16 v[88:103], v[124:127], v[188:191], v[88:103]
    ds_read_b128 v[124:127], v4 offset:46080
    s_waitcnt vmcnt(6)
    s_waitcnt lgkmcnt(4)
    v_mfma_f32_32x32x16_bf16 v[8:23], v[104:107], v[192:195], v[8:23]
    ds_read_b128 v[104:107], v4 offset:47104
    buffer_load_dword v144, v177, s[8:11], s36 offen offset:0 sc1
    v_mfma_f32_32x32x16_bf16 v[24:39], v[108:111], v[192:195], v[24:39]
    ds_read_b128 v[108:111], v4 offset:48128
    buffer_load_dwordx4 v[212:215], v3, s[8:11], s34 offen offset:3072 sc1
    s_add_u32 s34, s34, 4096
    s_waitcnt lgkmcnt(4)
    v_mfma_f32_32x32x16_bf16 v[40:55], v[112:115], v[192:195], v[40:55]
    ds_read_b128 v[112:115], v4 offset:49152
    v_mfma_f32_32x32x16_bf16 v[56:71], v[116:119], v[192:195], v[56:71]
    ds_read_b128 v[116:119], v4 offset:50176
    buffer_load_dword v145, v177, s[8:11], s36 offen offset:128 sc1
    s_waitcnt lgkmcnt(4)
    v_mfma_f32_32x32x16_bf16 v[72:87], v[120:123], v[192:195], v[72:87]
    ds_read_b128 v[120:123], v4 offset:51200
    buffer_load_dwordx4 v[216:219], v3, s[8:11], s34 offen offset:0 sc1
    v_mfma_f32_32x32x16_bf16 v[88:103], v[124:127], v[192:195], v[88:103]
    ds_read_b128 v[124:127], v4 offset:52224
    s_waitcnt lgkmcnt(4)
    v_mfma_f32_32x32x16_bf16 v[8:23], v[104:107], v[196:199], v[8:23]
    s_barrier
    ds_read_b128 v[104:107], v4 offset:53248
    buffer_load_dword v148, v177, s[8:11], s37 offen offset:0 sc1
    v_mfma_f32_32x32x16_bf16 v[24:39], v[108:111], v[196:199], v[24:39]
    ds_read_b128 v[108:111], v4 offset:54272
    buffer_load_dwordx4 v[220:223], v3, s[8:11], s34 offen offset:1024 sc1
    s_waitcnt lgkmcnt(4)
    v_mfma_f32_32x32x16_bf16 v[40:55], v[112:115], v[196:199], v[40:55]
    ds_read_b128 v[112:115], v4 offset:55296
    v_mfma_f32_32x32x16_bf16 v[56:71], v[116:119], v[196:199], v[56:71]
    ds_read_b128 v[116:119], v4 offset:56320
    buffer_load_dword v149, v177, s[8:11], s37 offen offset:128 sc1
    s_waitcnt lgkmcnt(4)
    v_mfma_f32_32x32x16_bf16 v[72:87], v[120:123], v[196:199], v[72:87]
    ds_read_b128 v[120:123], v4 offset:57344
    buffer_load_dwordx4 v[224:227], v3, s[8:11], s34 offen offset:2048 sc1
    v_mfma_f32_32x32x16_bf16 v[88:103], v[124:127], v[196:199], v[88:103]
    ds_read_b128 v[124:127], v4 offset:58368
    s_waitcnt vmcnt(10)
    s_waitcnt lgkmcnt(4)
    v_mfma_f32_32x32x16_bf16 v[8:23], v[104:107], v[200:203], v[8:23]
    ds_read_b128 v[104:107], v4 offset:59392
    buffer_load_dword v152, v177, s[8:11], s36 offen offset:512 sc1
    v_mfma_f32_32x32x16_bf16 v[24:39], v[108:111], v[200:203], v[24:39]
    ds_read_b128 v[108:111], v4 offset:60416
    buffer_load_dwordx4 v[228:231], v3, s[8:11], s34 offen offset:3072 sc1
    s_add_u32 s34, s34, 4096
    s_waitcnt lgkmcnt(4)
    v_mfma_f32_32x32x16_bf16 v[40:55], v[112:115], v[200:203], v[40:55]
    ds_read_b128 v[112:115], v4 offset:61440
    v_mfma_f32_32x32x16_bf16 v[56:71], v[116:119], v[200:203], v[56:71]
    ds_read_b128 v[116:119], v4 offset:62464
    buffer_load_dword v153, v177, s[8:11], s36 offen offset:640 sc1
    s_waitcnt lgkmcnt(4)
    v_mfma_f32_32x32x16_bf16 v[72:87], v[120:123], v[200:203], v[72:87]
    ds_read_b128 v[120:123], v4 offset:63488
    buffer_load_dwordx4 v[232:235], v3, s[8:11], s34 offen offset:0 sc1
    v_mfma_f32_32x32x16_bf16 v[88:103], v[124:127], v[200:203], v[88:103]
    ds_read_b128 v[124:127], v4 offset:64512
    s_waitcnt lgkmcnt(4)
    v_mfma_f32_32x32x16_bf16 v[8:23], v[104:107], v[204:207], v[8:23]
    ds_read_b128 v[104:107], v5 offset:0
    buffer_load_dword v156, v177, s[8:11], s37 offen offset:512 sc1
    v_mfma_f32_32x32x16_bf16 v[24:39], v[108:111], v[204:207], v[24:39]
    ds_read_b128 v[108:111], v5 offset:1024
    buffer_load_dwordx4 v[184:187], v3, s[8:11], s34 offen offset:1024 sc1
    s_waitcnt lgkmcnt(4)
    v_mfma_f32_32x32x16_bf16 v[40:55], v[112:115], v[204:207], v[40:55]
    ds_read_b128 v[112:115], v5 offset:2048
    v_mfma_f32_32x32x16_bf16 v[56:71], v[116:119], v[204:207], v[56:71]
    ds_read_b128 v[116:119], v5 offset:3072
    buffer_load_dword v157, v177, s[8:11], s37 offen offset:640 sc1
    s_waitcnt lgkmcnt(4)
    v_mfma_f32_32x32x16_bf16 v[72:87], v[120:123], v[204:207], v[72:87]
    ds_read_b128 v[120:123], v5 offset:4096
    buffer_load_dwordx4 v[188:191], v3, s[8:11], s34 offen offset:2048 sc1
    v_mfma_f32_32x32x16_bf16 v[88:103], v[124:127], v[204:207], v[88:103]
    ds_read_b128 v[124:127], v5 offset:5120
    s_waitcnt vmcnt(14)
    s_waitcnt lgkmcnt(4)
    v_mfma_f32_32x32x16_bf16 v[8:23], v[104:107], v[208:211], v[8:23]
    ds_read_b128 v[104:107], v5 offset:6144
    buffer_load_dword v160, v177, s[8:11], s36 offen offset:1024 sc1
    v_mfma_f32_32x32x16_bf16 v[24:39], v[108:111], v[208:211], v[24:39]
    ds_read_b128 v[108:111], v5 offset:7168
    buffer_load_dwordx4 v[192:195], v3, s[8:11], s34 offen offset:3072 sc1
    s_add_u32 s34, s34, 4096
    s_waitcnt lgkmcnt(4)
    v_mfma_f32_32x32x16_bf16 v[40:55], v[112:115], v[208:211], v[40:55]
    ds_read_b128 v[112:115], v5 offset:8192
    v_mfma_f32_32x32x16_bf16 v[56:71], v[116:119], v[208:211], v[56:71]
    ds_read_b128 v[116:119], v5 offset:9216
    buffer_load_dword v161, v177, s[8:11], s36 offen offset:1152 sc1
    s_waitcnt lgkmcnt(4)
    v_mfma_f32_32x32x16_bf16 v[72:87], v[120:123], v[208:211], v[72:87]
    ds_read_b128 v[120:123], v5 offset:10240
    buffer_load_dwordx4 v[196:199], v3, s[8:11], s34 offen offset:0 sc1
    v_mfma_f32_32x32x16_bf16 v[88:103], v[124:127], v[208:211], v[88:103]
    ds_read_b128 v[124:127], v5 offset:11264
    s_waitcnt lgkmcnt(4)
    v_mfma_f32_32x32x16_bf16 v[8:23], v[104:107], v[212:215], v[8:23]
    s_barrier
    ds_read_b128 v[104:107], v4 offset:4096
    buffer_load_dword v164, v177, s[8:11], s37 offen offset:1024 sc1
    v_mfma_f32_32x32x16_bf16 v[24:39], v[108:111], v[212:215], v[24:39]
    ds_read_b128 v[108:111], v4 offset:5120
    buffer_load_dwordx4 v[200:203], v3, s[8:11], s34 offen offset:1024 sc1
    s_waitcnt lgkmcnt(4)
    v_mfma_f32_32x32x16_bf16 v[40:55], v[112:115], v[212:215], v[40:55]
    ds_read_b128 v[112:115], v4 offset:6144
    v_mfma_f32_32x32x16_bf16 v[56:71], v[116:119], v[212:215], v[56:71]
    ds_read_b128 v[116:119], v4 offset:7168
    buffer_load_dword v165, v177, s[8:11], s37 offen offset:1152 sc1
    s_waitcnt lgkmcnt(4)
    v_mfma_f32_32x32x16_bf16 v[72:87], v[120:123], v[212:215], v[72:87]
    ds_read_b128 v[120:123], v4 offset:8192
    buffer_load_dwordx4 v[204:207], v3, s[8:11], s34 offen offset:2048 sc1
    v_mfma_f32_32x32x16_bf16 v[88:103], v[124:127], v[212:215], v[88:103]
    ds_read_b128 v[124:127], v4 offset:9216
    s_waitcnt vmcnt(18)
    s_waitcnt lgkmcnt(4)
    v_mfma_f32_32x32x16_bf16 v[8:23], v[104:107], v[216:219], v[8:23]
    ds_read_b128 v[104:107], v4 offset:10240
    v_mfma_f32_32x32x16_bf16 v[24:39], v[108:111], v[216:219], v[24:39]
    ds_read_b128 v[108:111], v4 offset:11264
    buffer_load_dwordx4 v[208:211], v3, s[8:11], s34 offen offset:3072 sc1
    s_add_u32 s34, s34, 4096
    s_waitcnt lgkmcnt(4)
    v_mfma_f32_32x32x16_bf16 v[40:55], v[112:115], v[216:219], v[40:55]
    ds_read_b128 v[112:115], v4 offset:12288
    v_mfma_f32_32x32x16_bf16 v[56:71], v[116:119], v[216:219], v[56:71]
    ds_read_b128 v[116:119], v4 offset:13312
    s_waitcnt lgkmcnt(4)
    v_mfma_f32_32x32x16_bf16 v[72:87], v[120:123], v[216:219], v[72:87]
    ds_read_b128 v[120:123], v4 offset:14336
    v_mfma_f32_32x32x16_bf16 v[88:103], v[124:127], v[216:219], v[88:103]
    ds_read_b128 v[124:127], v4 offset:15360
    s_waitcnt lgkmcnt(4)
    v_mfma_f32_32x32x16_bf16 v[8:23], v[104:107], v[220:223], v[8:23]
    ds_read_b128 v[104:107], v4 offset:16384
    v_mfma_f32_32x32x16_bf16 v[24:39], v[108:111], v[220:223], v[24:39]
    ds_read_b128 v[108:111], v4 offset:17408
    buffer_load_dwordx4 v[212:215], v3, s[8:11], s34 offen offset:0 sc1
    s_waitcnt lgkmcnt(4)
    v_mfma_f32_32x32x16_bf16 v[40:55], v[112:115], v[220:223], v[40:55]
    ds_read_b128 v[112:115], v4 offset:18432
    v_mfma_f32_32x32x16_bf16 v[56:71], v[116:119], v[220:223], v[56:71]
    ds_read_b128 v[116:119], v4 offset:19456
    s_waitcnt lgkmcnt(4)
    v_mfma_f32_32x32x16_bf16 v[72:87], v[120:123], v[220:223], v[72:87]
    ds_read_b128 v[120:123], v4 offset:20480
    v_mfma_f32_32x32x16_bf16 v[88:103], v[124:127], v[220:223], v[88:103]
    ds_read_b128 v[124:127], v4 offset:21504
    s_waitcnt vmcnt(16)
    s_waitcnt lgkmcnt(4)
    v_mfma_f32_32x32x16_bf16 v[8:23], v[104:107], v[224:227], v[8:23]
    ds_read_b128 v[104:107], v4 offset:22528
    s_waitcnt vmcnt(3)
    v_add_f32 v128, v128, v136
    v_mfma_f32_32x32x16_bf16 v[24:39], v[108:111], v[224:227], v[24:39]
    ds_read_b128 v[108:111], v4 offset:23552
    buffer_load_dwordx4 v[216:219], v3, s[8:11], s34 offen offset:1024 sc1
    s_waitcnt lgkmcnt(4)
    v_mfma_f32_32x32x16_bf16 v[40:55], v[112:115], v[224:227], v[40:55]
    ds_read_b128 v[112:115], v4 offset:24576
    v_add_f32 v129, v129, v137
    v_add_f32 v130, v130, v138
    v_mfma_f32_32x32x16_bf16 v[56:71], v[116:119], v[224:227], v[56:71]
    ds_read_b128 v[116:119], v4 offset:25600
    v_add_f32 v131, v131, v139
    v_add_f32 v132, v132, v140
    s_waitcnt lgkmcnt(4)
    v_mfma_f32_32x32x16_bf16 v[72:87], v[120:123], v[224:227], v[72:87]
    ds_read_b128 v[120:123], v4 offset:26624
    v_add_f32 v133, v133, v141
    v_add_f32 v134, v134, v142
    v_mfma_f32_32x32x16_bf16 v[88:103], v[124:127], v[224:227], v[88:103]
    ds_read_b128 v[124:127], v4 offset:27648
    v_add_f32 v135, v135, v143
    v_add_f32 v128, v128, v132
    s_waitcnt lgkmcnt(4)
    v_mfma_f32_32x32x16_bf16 v[8:23], v[104:107], v[228:231], v[8:23]
    s_barrier
    ds_read_b128 v[104:107], v3 offset:0
    v_add_f32 v129, v129, v133
    v_add_f32 v130, v130, v134
    v_mfma_f32_32x32x16_bf16 v[24:39], v[108:111], v[228:231], v[24:39]
    ds_read_b128 v[108:111], v3 offset:1024
    buffer_load_dwordx4 v[220:223], v3, s[8:11], s34 offen offset:2048 sc1
    s_waitcnt lgkmcnt(4)
    v_mfma_f32_32x32x16_bf16 v[40:55], v[112:115], v[228:231], v[40:55]
    ds_read_b128 v[112:115], v3 offset:2048
    v_add_f32 v131, v131, v135
    v_add_f32 v128, v128, v130
    v_mfma_f32_32x32x16_bf16 v[56:71], v[116:119], v[228:231], v[56:71]
    ds_read_b128 v[116:119], v3 offset:3072
    v_add_f32 v129, v129, v131
    v_add_f32 v128, v128, v129
    s_waitcnt lgkmcnt(4)
    v_mfma_f32_32x32x16_bf16 v[72:87], v[120:123], v[228:231], v[72:87]
    ds_read_b128 v[120:123], v3 offset:4096
    v_mov_b32 v169, v128
    s_nop 1
    v_mfma_f32_32x32x16_bf16 v[88:103], v[124:127], v[228:231], v[88:103]
    ds_read_b128 v[124:127], v3 offset:5120
    v_permlane32_swap_b32 v128, v169
    s_nop 1
    s_waitcnt vmcnt(14)
    s_waitcnt lgkmcnt(4)
    v_mfma_f32_32x32x16_bf16 v[8:23], v[104:107], v[232:235], v[8:23]
    ds_read_b128 v[104:107], v3 offset:6144
    v_mul_f32 v168, 0xbb000000, v128
    v_mul_f32 v169, 0x3b000000, v169
    v_mfma_f32_32x32x16_bf16 v[24:39], v[108:111], v[232:235], v[24:39]
    ds_read_b128 v[108:111], v3 offset:7168
    buffer_load_dwordx4 v[224:227], v3, s[8:11], s34 offen offset:3072 sc1
    s_add_u32 s34, s34, 4096
    s_waitcnt lgkmcnt(4)
    v_mfma_f32_32x32x16_bf16 v[40:55], v[112:115], v[232:235], v[40:55]
    ds_read_b128 v[112:115], v3 offset:8192
    v_fma_f32 v169, -v168, v168, v169
    v_max_f32 v169, 0, v169
    v_mfma_f32_32x32x16_bf16 v[56:71], v[116:119], v[232:235], v[56:71]
    ds_read_b128 v[116:119], v3 offset:9216
    v_add_f32 v169, 0x3727c5ac, v169
    v_rsq_f32 v170, v169
    s_waitcnt lgkmcnt(4)
    v_mfma_f32_32x32x16_bf16 v[72:87], v[120:123], v[232:235], v[72:87]
    ds_read_b128 v[120:123], v3 offset:10240
    s_nop 0
    v_cvt_pk_bf16_f32 v180, v168, v168
    v_mfma_f32_32x32x16_bf16 v[88:103], v[124:127], v[232:235], v[88:103]
    ds_read_b128 v[124:127], v3 offset:11264
    v_and_b32 v169, 0xffff0000, v180
    v_sub_f32 v169, v168, v169
    s_waitcnt lgkmcnt(4)
    v_mfma_f32_32x32x16_bf16 v[8:23], v[104:107], v[184:187], v[8:23]
    ds_read_b128 v[104:107], v3 offset:12288
    v_mov_b32 v181, v180
    v_cvt_pk_bf16_f32 v182, v169, v169
    v_mfma_f32_32x32x16_bf16 v[24:39], v[108:111], v[184:187], v[24:39]
    ds_read_b128 v[108:111], v3 offset:13312
    buffer_load_dwordx4 v[228:231], v3, s[8:11], s34 offen offset:0 sc1
    s_waitcnt lgkmcnt(4)
    v_mfma_f32_32x32x16_bf16 v[40:55], v[112:115], v[184:187], v[40:55]
    ds_read_b128 v[112:115], v3 offset:14336
    v_mov_b32 v183, 0
    v_perm_b32 v146, v145, v144, s59
    v_mfma_f32_32x32x16_bf16 v[56:71], v[116:119], v[184:187], v[56:71]
    ds_read_b128 v[116:119], v3 offset:15360
    v_perm_b32 v150, v149, v148, s59
    v_perm_b32 v154, v153, v152, s59
    s_waitcnt lgkmcnt(4)
    v_mfma_f32_32x32x16_bf16 v[72:87], v[120:123], v[184:187], v[72:87]
    ds_read_b128 v[120:123], v3 offset:16384
    v_perm_b32 v158, v157, v156, s59
    v_perm_b32 v162, v161, v160, s59
    v_mfma_f32_32x32x16_bf16 v[88:103], v[124:127], v[184:187], v[88:103]
    ds_read_b128 v[124:127], v3 offset:17408
    v_perm_b32 v166, v165, v164, s59
    v_mul_f32 v172, v170, v170
    s_waitcnt vmcnt(12)
    s_waitcnt lgkmcnt(4)
    v_mfma_f32_32x32x16_bf16 v[8:23], v[104:107], v[188:191], v[8:23]
    ds_read_b128 v[104:107], v3 offset:18432
    v_mul_f32 v173, v170, v170
    v_mfma_f32_32x32x16_bf16 v[8:23], v[144:147], v[180:183], v[8:23]
    v_mfma_f32_32x32x16_bf16 v[24:39], v[108:111], v[188:191], v[24:39]
    ds_read_b128 v[108:111], v3 offset:19456
    buffer_load_dwordx4 v[232:235], v3, s[8:11], s34 offen offset:1024 sc1
    s_waitcnt lgkmcnt(4)
    v_mfma_f32_32x32x16_bf16 v[40:55], v[112:115], v[188:191], v[40:55]
    ds_read_b128 v[112:115], v3 offset:20480
    v_mfma_f32_32x32x16_bf16 v[24:39], v[148:151], v[180:183], v[24:39]
    v_mfma_f32_32x32x16_bf16 v[56:71], v[116:119], v[188:191], v[56:71]
    ds_read_b128 v[116:119], v3 offset:21504
    v_mfma_f32_32x32x16_bf16 v[40:55], v[152:155], v[180:183], v[40:55]
    s_waitcnt lgkmcnt(4)
    v_mfma_f32_32x32x16_bf16 v[72:87], v[120:123], v[188:191], v[72:87]
    ds_read_b128 v[120:123], v3 offset:22528
    v_mfma_f32_32x32x16_bf16 v[56:71], v[156:159], v[180:183], v[56:71]
    v_mfma_f32_32x32x16_bf16 v[88:103], v[124:127], v[188:191], v[88:103]
    ds_read_b128 v[124:127], v3 offset:23552
    v_mfma_f32_32x32x16_bf16 v[72:87], v[160:163], v[180:183], v[72:87]
    s_waitcnt lgkmcnt(4)
    v_mfma_f32_32x32x16_bf16 v[8:23], v[104:107], v[192:195], v[8:23]
    s_barrier
    ds_read_b128 v[104:107], v3 offset:24576
    v_mfma_f32_32x32x16_bf16 v[88:103], v[164:167], v[180:183], v[88:103]
    v_mfma_f32_32x32x16_bf16 v[24:39], v[108:111], v[192:195], v[24:39]
    ds_read_b128 v[108:111], v3 offset:25600
    buffer_load_dwordx4 v[184:187], v3, s[8:11], s34 offen offset:2048 sc1
    s_waitcnt lgkmcnt(4)
    v_mfma_f32_32x32x16_bf16 v[40:55], v[112:115], v[192:195], v[40:55]
    ds_read_b128 v[112:115], v3 offset:26624
    v_mfma_f32_32x32x16_bf16 v[56:71], v[116:119], v[192:195], v[56:71]
    ds_read_b128 v[116:119], v3 offset:27648
    s_waitcnt lgkmcnt(4)
    v_mfma_f32_32x32x16_bf16 v[72:87], v[120:123], v[192:195], v[72:87]
    ds_read_b128 v[120:123], v3 offset:28672
    v_mfma_f32_32x32x16_bf16 v[88:103], v[124:127], v[192:195], v[88:103]
    ds_read_b128 v[124:127], v3 offset:29696
    s_waitcnt vmcnt(10)
    s_waitcnt lgkmcnt(4)
    v_mfma_f32_32x32x16_bf16 v[8:23], v[104:107], v[196:199], v[8:23]
    ds_read_b128 v[104:107], v3 offset:30720
    v_mfma_f32_32x32x16_bf16 v[24:39], v[108:111], v[196:199], v[24:39]
    ds_read_b128 v[108:111], v3 offset:31744
    buffer_load_dwordx4 v[188:191], v3, s[8:11], s34 offen offset:3072 sc1
    s_add_u32 s34, s34, 4096
    s_waitcnt lgkmcnt(4)
    v_mfma_f32_32x32x16_bf16 v[40:55], v[112:115], v[196:199], v[40:55]
    ds_read_b128 v[112:115], v3 offset:32768
    v_mfma_f32_32x32x16_bf16 v[56:71], v[116:119], v[196:199], v[56:71]
    ds_read_b128 v[116:119], v3 offset:33792
    s_waitcnt lgkmcnt(4)
    v_mfma_f32_32x32x16_bf16 v[72:87], v[120:123], v[196:199], v[72:87]
    ds_read_b128 v[120:123], v3 offset:34816
    v_mfma_f32_32x32x16_bf16 v[88:103], v[124:127], v[196:199], v[88:103]
    ds_read_b128 v[124:127], v3 offset:35840
    s_waitcnt lgkmcnt(4)
    v_mfma_f32_32x32x16_bf16 v[8:23], v[104:107], v[200:203], v[8:23]
    ds_read_b128 v[104:107], v3 offset:36864
    v_mfma_f32_32x32x16_bf16 v[24:39], v[108:111], v[200:203], v[24:39]
    ds_read_b128 v[108:111], v3 offset:37888
    buffer_load_dwordx4 v[192:195], v3, s[8:11], s34 offen offset:0 sc1
    s_waitcnt lgkmcnt(4)
    v_mfma_f32_32x32x16_bf16 v[40:55], v[112:115], v[200:203], v[40:55]
    ds_read_b128 v[112:115], v3 offset:38912
    v_mfma_f32_32x32x16_bf16 v[56:71], v[116:119], v[200:203], v[56:71]
    ds_read_b128 v[116:119], v3 offset:39936
    s_waitcnt lgkmcnt(4)
    v_mfma_f32_32x32x16_bf16 v[72:87], v[120:123], v[200:203], v[72:87]
    ds_read_b128 v[120:123], v3 offset:40960
    v_mfma_f32_32x32x16_bf16 v[88:103], v[124:127], v[200:203], v[88:103]
    ds_read_b128 v[124:127], v3 offset:41984
    s_waitcnt vmcnt(9)
    s_waitcnt lgkmcnt(4)
    v_mfma_f32_32x32x16_bf16 v[8:23], v[104:107], v[204:207], v[8:23]
    ds_read_b128 v[104:107], v3 offset:43008
    v_mfma_f32_32x32x16_bf16 v[24:39], v[108:111], v[204:207], v[24:39]
    ds_read_b128 v[108:111], v3 offset:44032
    buffer_load_dwordx4 v[196:199], v3, s[8:11], s34 offen offset:1024 sc1
    s_waitcnt lgkmcnt(4)
    v_mfma_f32_32x32x16_bf16 v[40:55], v[112:115], v[204:207], v[40:55]
    ds_read_b128 v[112:115], v3 offset:45056
    v_mfma_f32_32x32x16_bf16 v[56:71], v[116:119], v[204:207], v[56:71]
    ds_read_b128 v[116:119], v3 offset:46080
    s_waitcnt lgkmcnt(4)
    v_mfma_f32_32x32x16_bf16 v[72:87], v[120:123], v[204:207], v[72:87]
    ds_read_b128 v[120:123], v3 offset:47104
    v_mfma_f32_32x32x16_bf16 v[88:103], v[124:127], v[204:207], v[88:103]
    ds_read_b128 v[124:127], v3 offset:48128
    s_waitcnt lgkmcnt(4)
    v_mfma_f32_32x32x16_bf16 v[8:23], v[104:107], v[208:211], v[8:23]
    s_barrier
    ds_read_b128 v[104:107], v4 offset:28672
    v_mfma_f32_32x32x16_bf16 v[24:39], v[108:111], v[208:211], v[24:39]
    ds_read_b128 v[108:111], v4 offset:29696
    buffer_load_dwordx4 v[200:203], v3, s[8:11], s34 offen offset:2048 sc1
    s_waitcnt lgkmcnt(4)
    v_mfma_f32_32x32x16_bf16 v[40:55], v[112:115], v[208:211], v[40:55]
    ds_read_b128 v[112:115], v4 offset:30720
    v_mfma_f32_32x32x16_bf16 v[56:71], v[116:119], v[208:211], v[56:71]
    ds_read_b128 v[116:119], v4 offset:31744
    s_waitcnt lgkmcnt(4)
    v_mfma_f32_32x32x16_bf16 v[72:87], v[120:123], v[208:211], v[72:87]
    ds_read_b128 v[120:123], v4 offset:32768
    v_mfma_f32_32x32x16_bf16 v[88:103], v[124:127], v[208:211], v[88:103]
    ds_read_b128 v[124:127], v4 offset:33792
    s_waitcnt vmcnt(9)
    s_waitcnt lgkmcnt(4)
    v_mfma_f32_32x32x16_bf16 v[8:23], v[104:107], v[212:215], v[8:23]
    ds_read_b128 v[104:107], v4 offset:34816
    v_mfma_f32_32x32x16_bf16 v[24:39], v[108:111], v[212:215], v[24:39]
    ds_read_b128 v[108:111], v4 offset:35840
    buffer_load_dwordx4 v[204:207], v3, s[8:11], s34 offen offset:3072 sc1
    s_add_u32 s34, s34, 4096
    s_waitcnt lgkmcnt(4)
    v_mfma_f32_32x32x16_bf16 v[40:55], v[112:115], v[212:215], v[40:55]
    ds_read_b128 v[112:115], v4 offset:36864
    v_mfma_f32_32x32x16_bf16 v[56:71], v[116:119], v[212:215], v[56:71]
    ds_read_b128 v[116:119], v4 offset:37888
    s_waitcnt lgkmcnt(4)
    v_mfma_f32_32x32x16_bf16 v[72:87], v[120:123], v[212:215], v[72:87]
    ds_read_b128 v[120:123], v4 offset:38912
    v_mfma_f32_32x32x16_bf16 v[88:103], v[124:127], v[212:215], v[88:103]
    ds_read_b128 v[124:127], v4 offset:39936
    s_waitcnt lgkmcnt(4)
    v_mfma_f32_32x32x16_bf16 v[8:23], v[104:107], v[216:219], v[8:23]
    ds_read_b128 v[104:107], v4 offset:40960
    v_mfma_f32_32x32x16_bf16 v[24:39], v[108:111], v[216:219], v[24:39]
    ds_read_b128 v[108:111], v4 offset:41984
    s_waitcnt lgkmcnt(4)
    v_mfma_f32_32x32x16_bf16 v[40:55], v[112:115], v[216:219], v[40:55]
    ds_read_b128 v[112:115], v4 offset:43008
    v_mfma_f32_32x32x16_bf16 v[56:71], v[116:119], v[216:219], v[56:71]
    ds_read_b128 v[116:119], v4 offset:44032
    s_waitcnt lgkmcnt(4)
    v_mfma_f32_32x32x16_bf16 v[72:87], v[120:123], v[216:219], v[72:87]
    ds_read_b128 v[120:123], v4 offset:45056
    v_mfma_f32_32x32x16_bf16 v[88:103], v[124:127], v[216:219], v[88:103]
    ds_read_b128 v[124:127], v4 offset:46080
    s_waitcnt vmcnt(8)
    s_waitcnt lgkmcnt(4)
    v_mfma_f32_32x32x16_bf16 v[8:23], v[104:107], v[220:223], v[8:23]
    ds_read_b128 v[104:107], v4 offset:47104
    v_mfma_f32_32x32x16_bf16 v[24:39], v[108:111], v[220:223], v[24:39]
    ds_read_b128 v[108:111], v4 offset:48128
    s_waitcnt lgkmcnt(4)
    v_mfma_f32_32x32x16_bf16 v[40:55], v[112:115], v[220:223], v[40:55]
    ds_read_b128 v[112:115], v4 offset:49152
    v_mfma_f32_32x32x16_bf16 v[56:71], v[116:119], v[220:223], v[56:71]
    ds_read_b128 v[116:119], v4 offset:50176
    s_waitcnt lgkmcnt(4)
    v_mfma_f32_32x32x16_bf16 v[72:87], v[120:123], v[220:223], v[72:87]
    ds_read_b128 v[120:123], v4 offset:51200
    v_mfma_f32_32x32x16_bf16 v[88:103], v[124:127], v[220:223], v[88:103]
    ds_read_b128 v[124:127], v4 offset:52224
    s_waitcnt lgkmcnt(4)
    v_mfma_f32_32x32x16_bf16 v[8:23], v[104:107], v[224:227], v[8:23]
    s_barrier
    ds_read_b128 v[104:107], v4 offset:53248
    v_mfma_f32_32x32x16_bf16 v[24:39], v[108:111], v[224:227], v[24:39]
    ds_read_b128 v[108:111], v4 offset:54272
    s_waitcnt lgkmcnt(4)
    v_mfma_f32_32x32x16_bf16 v[40:55], v[112:115], v[224:227], v[40:55]
    ds_read_b128 v[112:115], v4 offset:59392
    v_mfma_f32_32x32x16_bf16 v[56:71], v[116:119], v[224:227], v[56:71]
    ds_read_b128 v[116:119], v4 offset:60416
    s_waitcnt lgkmcnt(4)
    v_mfma_f32_32x32x16_bf16 v[72:87], v[120:123], v[224:227], v[72:87]
    ds_read_b128 v[120:123], v5 offset:0
    v_mfma_f32_32x32x16_bf16 v[88:103], v[124:127], v[224:227], v[88:103]
    ds_read_b128 v[124:127], v5 offset:1024
    s_waitcnt vmcnt(6)
    s_waitcnt lgkmcnt(4)
    v_mfma_f32_32x32x16_bf16 v[8:23], v[104:107], v[228:231], v[8:23]
    ds_read_b128 v[104:107], v5 offset:6144
    v_mfma_f32_32x32x16_bf16 v[24:39], v[108:111], v[228:231], v[24:39]
    ds_read_b128 v[108:111], v5 offset:7168
    s_waitcnt lgkmcnt(4)
    v_mfma_f32_32x32x16_bf16 v[8:23], v[112:115], v[232:235], v[8:23]
    ds_read_b128 v[112:115], v4 offset:4096
    v_mfma_f32_32x32x16_bf16 v[24:39], v[116:119], v[232:235], v[24:39]
    ds_read_b128 v[116:119], v4 offset:5120
    s_waitcnt vmcnt(4)
    s_waitcnt lgkmcnt(4)
    v_mfma_f32_32x32x16_bf16 v[8:23], v[120:123], v[184:187], v[8:23]
    ds_read_b128 v[120:123], v4 offset:10240
    v_mfma_f32_32x32x16_bf16 v[24:39], v[124:127], v[184:187], v[24:39]
    ds_read_b128 v[124:127], v4 offset:11264
    s_waitcnt lgkmcnt(4)
    v_mfma_f32_32x32x16_bf16 v[8:23], v[104:107], v[188:191], v[8:23]
    ds_read_b128 v[104:107], v4 offset:16384
    v_mfma_f32_32x32x16_bf16 v[24:39], v[108:111], v[188:191], v[24:39]
    ds_read_b128 v[108:111], v4 offset:17408
    s_waitcnt vmcnt(2)
    s_waitcnt lgkmcnt(4)
    v_mfma_f32_32x32x16_bf16 v[8:23], v[112:115], v[192:195], v[8:23]
    ds_read_b128 v[112:115], v4 offset:22528
    v_mfma_f32_32x32x16_bf16 v[24:39], v[116:119], v[192:195], v[24:39]
    ds_read_b128 v[116:119], v4 offset:23552
    s_waitcnt lgkmcnt(4)
    v_mfma_f32_32x32x16_bf16 v[8:23], v[120:123], v[196:199], v[8:23]
    ds_read_b128 v[120:123], v4 offset:55296
    v_mfma_f32_32x32x16_bf16 v[24:39], v[124:127], v[196:199], v[24:39]
    ds_read_b128 v[124:127], v4 offset:56320
    s_waitcnt vmcnt(0)
    s_waitcnt lgkmcnt(4)
    v_mfma_f32_32x32x16_bf16 v[8:23], v[104:107], v[200:203], v[8:23]
    ds_read_b128 v[104:107], v4 offset:61440
    v_mfma_f32_32x32x16_bf16 v[24:39], v[108:111], v[200:203], v[24:39]
    ds_read_b128 v[108:111], v4 offset:62464
    s_waitcnt lgkmcnt(4)
    v_mfma_f32_32x32x16_bf16 v[8:23], v[112:115], v[204:207], v[8:23]
    ds_read_b128 v[112:115], v5 offset:2048
    v_mfma_f32_32x32x16_bf16 v[24:39], v[116:119], v[204:207], v[24:39]
    ds_read_b128 v[116:119], v5 offset:3072
    s_waitcnt lgkmcnt(4)
    v_mfma_f32_32x32x16_bf16 v[40:55], v[120:123], v[228:231], v[40:55]
    ds_read_b128 v[120:123], v5 offset:8192
    v_mfma_f32_32x32x16_bf16 v[56:71], v[124:127], v[228:231], v[56:71]
    ds_read_b128 v[124:127], v5 offset:9216
    s_waitcnt lgkmcnt(4)
    v_mfma_f32_32x32x16_bf16 v[40:55], v[104:107], v[232:235], v[40:55]
    ds_read_b128 v[104:107], v4 offset:6144
    v_mfma_f32_32x32x16_bf16 v[56:71], v[108:111], v[232:235], v[56:71]
    ds_read_b128 v[108:111], v4 offset:7168
    v_mul_f32 v8, v8, v172
    v_mul_f32 v9, v9, v172
    v_mul_f32 v10, v10, v172
    v_mul_f32 v11, v11, v172
    s_waitcnt lgkmcnt(4)
    v_mfma_f32_32x32x16_bf16 v[40:55], v[112:115], v[184:187], v[40:55]
    ds_read_b128 v[112:115], v4 offset:12288
    v_mul_f32 v12, v12, v172
    v_mul_f32 v13, v13, v172
    v_mul_f32 v14, v14, v172
    v_mul_f32 v15, v15, v172
    v_mfma_f32_32x32x16_bf16 v[56:71], v[116:119], v[184:187], v[56:71]
    ds_read_b128 v[116:119], v4 offset:13312
    v_mul_f32 v16, v16, v172
    v_mul_f32 v17, v17, v172
    v_mul_f32 v18, v18, v172
    v_mul_f32 v19, v19, v172
    s_waitcnt lgkmcnt(4)
    v_mfma_f32_32x32x16_bf16 v[40:55], v[120:123], v[188:191], v[40:55]
    ds_read_b128 v[120:123], v4 offset:18432
    v_mul_f32 v20, v20, v172
    v_mul_f32 v21, v21, v172
    v_mul_f32 v22, v22, v172
    v_mul_f32 v23, v23, v172
    v_mfma_f32_32x32x16_bf16 v[56:71], v[124:127], v[188:191], v[56:71]
    ds_read_b128 v[124:127], v4 offset:19456
    v_mul_f32 v8, v8, v24
    v_mul_f32 v9, v9, v25
    v_mul_f32 v10, v10, v26
    v_mul_f32 v11, v11, v27
    s_waitcnt lgkmcnt(4)
    v_mfma_f32_32x32x16_bf16 v[40:55], v[104:107], v[192:195], v[40:55]
    ds_read_b128 v[104:107], v4 offset:24576
    v_mul_f32 v12, v12, v28
    v_mul_f32 v13, v13, v29
    v_mul_f32 v14, v14, v30
    v_mul_f32 v15, v15, v31
    v_mfma_f32_32x32x16_bf16 v[56:71], v[108:111], v[192:195], v[56:71]
    ds_read_b128 v[108:111], v4 offset:25600
    v_mul_f32 v16, v16, v32
    v_mul_f32 v17, v17, v33
    v_mul_f32 v18, v18, v34
    v_mul_f32 v19, v19, v35
    s_waitcnt lgkmcnt(4)
    v_mfma_f32_32x32x16_bf16 v[40:55], v[112:115], v[196:199], v[40:55]
    ds_read_b128 v[112:115], v4 offset:57344
    v_mul_f32 v20, v20, v36
    v_mul_f32 v21, v21, v37
    v_mul_f32 v22, v22, v38
    v_mul_f32 v23, v23, v39
    v_mfma_f32_32x32x16_bf16 v[56:71], v[116:119], v[196:199], v[56:71]
    ds_read_b128 v[116:119], v4 offset:58368
    v_cvt_pk_bf16_f32 v8, v8, v9
    v_cvt_pk_bf16_f32 v9, v10, v11
    v_cvt_pk_bf16_f32 v10, v12, v13
    v_cvt_pk_bf16_f32 v11, v14, v15
    s_waitcnt lgkmcnt(4)
    v_mfma_f32_32x32x16_bf16 v[40:55], v[120:123], v[200:203], v[40:55]
    ds_read_b128 v[120:123], v4 offset:63488
    v_cvt_pk_bf16_f32 v12, v16, v17
    v_cvt_pk_bf16_f32 v13, v18, v19
    v_cvt_pk_bf16_f32 v14, v20, v21
    v_cvt_pk_bf16_f32 v15, v22, v23
    v_mfma_f32_32x32x16_bf16 v[56:71], v[124:127], v[200:203], v[56:71]
    ds_read_b128 v[124:127], v4 offset:64512
    s_cmp_ge_u32 s33, 15
    s_cbranch_scc1 L_gsk_119
    s_add_u32 s39, s38, 0
    s_cmp_lg_u32 s22, 0
    s_cbranch_scc1 L_sts_120
    buffer_store_dwordx4 v[8:11], v3, s[8:11], s39 offen
    buffer_store_dwordx4 v[12:15], v3, s[8:11], s39 offen offset:1024
L_std_121:
L_gsk_119:
    s_waitcnt lgkmcnt(4)
    v_mfma_f32_32x32x16_bf16 v[40:55], v[104:107], v[204:207], v[40:55]
    ds_read_b128 v[104:107], v5 offset:4096
    v_mfma_f32_32x32x16_bf16 v[56:71], v[108:111], v[204:207], v[56:71]
    ds_read_b128 v[108:111], v5 offset:5120
    s_waitcnt lgkmcnt(4)
    v_mfma_f32_32x32x16_bf16 v[72:87], v[112:115], v[228:231], v[72:87]
    ds_read_b128 v[112:115], v5 offset:10240
    v_mfma_f32_32x32x16_bf16 v[88:103], v[116:119], v[228:231], v[88:103]
    ds_read_b128 v[116:119], v5 offset:11264
    s_waitcnt lgkmcnt(4)
    v_mfma_f32_32x32x16_bf16 v[72:87], v[120:123], v[232:235], v[72:87]
    ds_read_b128 v[120:123], v4 offset:8192
    v_mfma_f32_32x32x16_bf16 v[88:103], v[124:127], v[232:235], v[88:103]
    ds_read_b128 v[124:127], v4 offset:9216
    v_mul_f32 v40, v40, v172
    v_mul_f32 v41, v41, v172
    v_mul_f32 v42, v42, v172
    v_mul_f32 v43, v43, v172
    s_waitcnt lgkmcnt(4)
    v_mfma_f32_32x32x16_bf16 v[72:87], v[104:107], v[184:187], v[72:87]
    ds_read_b128 v[104:107], v4 offset:14336
    v_mul_f32 v44, v44, v172
    v_mul_f32 v45, v45, v172
    v_mul_f32 v46, v46, v172
    v_mul_f32 v47, v47, v172
    v_mfma_f32_32x32x16_bf16 v[88:103], v[108:111], v[184:187], v[88:103]
    ds_read_b128 v[108:111], v4 offset:15360
    v_mul_f32 v48, v48, v172
    v_mul_f32 v49, v49, v172
    v_mul_f32 v50, v50, v172
    v_mul_f32 v51, v51, v172
    s_waitcnt lgkmcnt(4)
    v_mfma_f32_32x32x16_bf16 v[72:87], v[112:115], v[188:191], v[72:87]
    ds_read_b128 v[112:115], v4 offset:20480
    v_mul_f32 v52, v52, v172
    v_mul_f32 v53, v53, v172
    v_mul_f32 v54, v54, v172
    v_mul_f32 v55, v55, v172
    v_mfma_f32_32x32x16_bf16 v[88:103], v[116:119], v[188:191], v[88:103]
    ds_read_b128 v[116:119], v4 offset:21504
    v_mul_f32 v40, v40, v56
    v_mul_f32 v41, v41, v57
    v_mul_f32 v42, v42, v58
    v_mul_f32 v43, v43, v59
    s_waitcnt lgkmcnt(4)
    v_mfma_f32_32x32x16_bf16 v[72:87], v[120:123], v[192:195], v[72:87]
    ds_read_b128 v[120:123], v4 offset:26624
    v_mul_f32 v44, v44, v60
    v_mul_f32 v45, v45, v61
    v_mul_f32 v46, v46, v62
    v_mul_f32 v47, v47, v63
    v_mfma_f32_32x32x16_bf16 v[88:103], v[124:127], v[192:195], v[88:103]
    ds_read_b128 v[124:127], v4 offset:27648
    v_mul_f32 v48, v48, v64
    v_mul_f32 v49, v49, v65
    v_mul_f32 v50, v50, v66
    v_mul_f32 v51, v51, v67
    s_waitcnt lgkmcnt(4)
    v_mfma_f32_32x32x16_bf16 v[72:87], v[104:107], v[196:199], v[72:87]
    v_mul_f32 v52, v52, v68
    v_mul_f32 v53, v53, v69
    v_mul_f32 v54, v54, v70
    v_mul_f32 v55, v55, v71
    v_mfma_f32_32x32x16_bf16 v[88:103], v[108:111], v[196:199], v[88:103]
    v_cvt_pk_bf16_f32 v40, v40, v41
    v_cvt_pk_bf16_f32 v41, v42, v43
    v_cvt_pk_bf16_f32 v42, v44, v45
    v_cvt_pk_bf16_f32 v43, v46, v47
    s_waitcnt lgkmcnt(2)
    v_mfma_f32_32x32x16_bf16 v[72:87], v[112:115], v[200:203], v[72:87]
    v_cvt_pk_bf16_f32 v44, v48, v49
    v_cvt_pk_bf16_f32 v45, v50, v51
    v_cvt_pk_bf16_f32 v46, v52, v53
    v_cvt_pk_bf16_f32 v47, v54, v55
    v_mfma_f32_32x32x16_bf16 v[88:103], v[116:119], v[200:203], v[88:103]
    s_cmp_ge_u32 s33, 14
    s_cbranch_scc1 L_gsk_122
    s_add_u32 s39, s38, 2048
    s_cmp_lg_u32 s22, 0
    s_cbranch_scc1 L_sts_123
    buffer_store_dwordx4 v[40:43], v3, s[8:11], s39 offen
    buffer_store_dwordx4 v[44:47], v3, s[8:11], s39 offen offset:1024
L_std_124:
L_gsk_122:
    s_waitcnt lgkmcnt(0)
    v_mfma_f32_32x32x16_bf16 v[72:87], v[120:123], v[204:207], v[72:87]
    v_mfma_f32_32x32x16_bf16 v[88:103], v[124:127], v[204:207], v[88:103]
L_gjoin_117:
    s_lshr_b32 s40, s16, 1
    s_lshl_b32 s41, s40, 10
    s_mul_i32 s40, s40, 3072
    s_add_u32 s41, s41, 1024
    s_add_u32 s46, s29, 147456
    s_add_u32 s47, s46, s41
    s_add_u32 s46, s46, s40
    buffer_load_dwordx4 v[192:195], v3, s[8:11], s47 offen
    buffer_load_dwordx4 v[196:199], v3, s[8:11], s46 offen
    s_add_u32 s46, s29, 151552
    s_add_u32 s47, s46, s41
    s_add_u32 s46, s46, s40
    buffer_load_dwordx4 v[200:203], v3, s[8:11], s47 offen
    buffer_load_dwordx4 v[204:207], v3, s[8:11], s46 offen
    s_add_u32 s46, s29, 155648
    s_add_u32 s47, s46, s41
    s_add_u32 s46, s46, s40
    buffer_load_dwordx4 v[208:211], v3, s[8:11], s47 offen
    buffer_load_dwordx4 v[212:215], v3, s[8:11], s46 offen
    s_add_u32 s46, s29, 159744
    s_add_u32 s47, s46, s41
    s_add_u32 s46, s46, s40
    buffer_load_dwordx4 v[216:219], v3, s[8:11], s47 offen
    buffer_load_dwordx4 v[220:223], v3, s[8:11], s46 offen
    v_pk_mul_f32 v[72:73], v[72:73], v[172:173]
    v_pk_mul_f32 v[74:75], v[74:75], v[172:173]
    v_pk_mul_f32 v[76:77], v[76:77], v[172:173]
    v_pk_mul_f32 v[78:79], v[78:79], v[172:173]
    v_pk_mul_f32 v[80:81], v[80:81], v[172:173]
    v_pk_mul_f32 v[82:83], v[82:83], v[172:173]
    v_pk_mul_f32 v[84:85], v[84:85], v[172:173]
    v_pk_mul_f32 v[86:87], v[86:87], v[172:173]
    v_pk_mul_f32 v[72:73], v[72:73], v[88:89]
    v_pk_mul_f32 v[74:75], v[74:75], v[90:91]
    v_pk_mul_f32 v[76:77], v[76:77], v[92:93]
    v_pk_mul_f32 v[78:79], v[78:79], v[94:95]
    v_pk_mul_f32 v[80:81], v[80:81], v[96:97]
    v_pk_mul_f32 v[82:83], v[82:83], v[98:99]
    v_pk_mul_f32 v[84:85], v[84:85], v[100:101]
    v_pk_mul_f32 v[86:87], v[86:87], v[102:103]
    v_cvt_pk_bf16_f32 v72, v72, v73
    v_cvt_pk_bf16_f32 v73, v74, v75
    v_cvt_pk_bf16_f32 v74, v76, v77
    v_cvt_pk_bf16_f32 v75, v78, v79
    v_cvt_pk_bf16_f32 v76, v80, v81
    v_cvt_pk_bf16_f32 v77, v82, v83
    v_cvt_pk_bf16_f32 v78, v84, v85
    v_cvt_pk_bf16_f32 v79, v86, v87
    s_cmp_ge_u32 s33, 14
    s_cbranch_scc1 L_gsk_127
    s_add_u32 s39, s38, 4096
    s_cmp_lg_u32 s22, 0
    s_cbranch_scc1 L_sts_128
    buffer_store_dwordx4 v[72:75], v3, s[8:11], s39 offen
    buffer_store_dwordx4 v[76:79], v3, s[8:11], s39 offen offset:1024
L_std_129:
L_gsk_127:
L_gdone_130:
    s_barrier
    s_add_u32 s61, s25, 4
    v_mov_b32 v2, s61
    s_mov_b64 exec, 1
    s_waitcnt vmcnt(0)
    s_cmp_lg_u32 s22, 0
    s_cbranch_scc1 L_sts_131
    buffer_store_dword v2, v253, s[8:11], s21 offen
L_std_132:
    s_mov_b64 exec, -1
    s_branch L_se_115
L_ld_114:
    s_cmp_lg_u32 s16, 7
    s_cbranch_scc1 L_w0_133
    s_and_b32 s63, s19, 1
    s_lshl_b32 s63, s63, 1
    s_lshl_b32 s63, 0x33333333, s63
    s_add_u32 s62, s25, 3
    s_mov_b32 exec_lo, s63
    s_mov_b32 exec_hi, 0
    s_mov_b32 s60, 0
    buffer_load_dwordx4 v[244:247], v254, s[8:11], s31 offen sc1
L_poll_134:
    buffer_load_dwordx4 v[248:251], v254, s[8:11], s31 offen sc1
    s_waitcnt vmcnt(1)
    v_min3_u32 v244, v244, v245, v246
    v_min_u32 v244, v244, v247
    v_cmp_gt_u32 vcc, s62, v244
    s_add_u32 s60, s60, 1
    s_cmp_gt_u32 s60, 0x4000
    s_cbranch_vccz L_polld_135
    buffer_load_dwordx4 v[244:247], v254, s[8:11], s31 offen sc1
    s_waitcnt vmcnt(1)
    v_min3_u32 v248, v248, v249, v250
    v_min_u32 v248, v248, v251
    v_cmp_gt_u32 vcc, s62, v248
    s_cbranch_scc1 L_polld_135
    s_nop 0
    s_cbranch_vccnz L_poll_134
L_polld_135:
    s_mov_b64 exec, -1
L_w0_133:
    s_cmp_lg_u32 s24, 0
    s_cbranch_scc1 L_ldl_136
    s_setprio 0
    s_waitcnt vmcnt(24)
    s_barrier
    s_waitcnt vmcnt(18)
    s_barrier
    s_waitcnt vmcnt(12)
    s_barrier
    s_mul_i32 s64, s30, 6
    s_add_u32 s65, s64, s28
    s_add_u32 m0, s64, 94208
    s_add_u32 s66, s65, 122880
    buffer_load_dwordx4 v3, s[8:11], s66 offen offset:0 lds
    buffer_load_dwordx4 v3, s[8:11], s66 offen offset:1024 lds
    buffer_load_dwordx4 v3, s[8:11], s66 offen offset:2048 lds
    buffer_load_dwordx4 v3, s[8:11], s66 offen offset:3072 lds
    s_add_u32 m0, s64, 98304
    s_add_u32 s66, s65, 126976
    buffer_load_dwordx4 v3, s[8:11], s66 offen offset:0 lds
    buffer_load_dwordx4 v3, s[8:11], s66 offen offset:1024 lds
    s_waitcnt vmcnt(12)
    s_barrier
    s_mul_i32 s64, s30, 6
    s_add_u32 s65, s64, s28
    s_add_u32 m0, s64, 118784
    s_add_u32 s66, s65, 147456
    buffer_load_dwordx4 v3, s[8:11], s66 offen offset:0 lds
    buffer_load_dwordx4 v3, s[8:11], s66 offen offset:1024 lds
    buffer_load_dwordx4 v3, s[8:11], s66 offen offset:2048 lds
    buffer_load_dwordx4 v3, s[8:11], s66 offen offset:3072 lds
    s_add_u32 m0, s64, 122880
    s_add_u32 s66, s65, 151552
    buffer_load_dwordx4 v3, s[8:11], s66 offen offset:0 lds
    buffer_load_dwordx4 v3, s[8:11], s66 offen offset:1024 lds
    s_mul_i32 s64, s30, 4
    s_add_u32 s65, s64, s29
    s_add_u32 m0, s64, 143360
    s_add_u32 s66, s65, 131072
    buffer_load_dwordx4 v3, s[8:11], s66 offen offset:0 lds
    buffer_load_dwordx4 v3, s[8:11], s66 offen offset:1024 lds
    buffer_load_dwordx4 v3, s[8:11], s66 offen offset:2048 lds
    buffer_load_dwordx4 v3, s[8:11], s66 offen offset:3072 lds
    s_waitcnt vmcnt(16)
    s_barrier
    s_mul_i32 s64, s30, 6
    s_add_u32 s65, s64, s28
    s_add_u32 m0, s64, 69632
    s_add_u32 s66, s65, 172032
    buffer_load_dwordx4 v3, s[8:11], s66 offen offset:0 lds
    buffer_load_dwordx4 v3, s[8:11], s66 offen offset:1024 lds
    buffer_load_dwordx4 v3, s[8:11], s66 offen offset:2048 lds
    buffer_load_dwordx4 v3, s[8:11], s66 offen offset:3072 lds
    s_add_u32 m0, s64, 73728
    s_add_u32 s66, s65, 176128
    buffer_load_dwordx4 v3, s[8:11], s66 offen offset:0 lds
    buffer_load_dwordx4 v3, s[8:11], s66 offen offset:1024 lds
    s_mul_i32 s64, s30, 4
    s_add_u32 s65, s64, s29
    s_add_u32 m0, s64, 49152
    s_add_u32 s66, s65, 0
    buffer_load_dwordx4 v3, s[8:11], s66 offen offset:0 lds
    buffer_load_dwordx4 v3, s[8:11], s66 offen offset:1024 lds
    buffer_load_dwordx4 v3, s[8:11], s66 offen offset:2048 lds
    buffer_load_dwordx4 v3, s[8:11], s66 offen offset:3072 lds
    s_waitcnt vmcnt(20)
    s_barrier
    s_mul_i32 s64, s30, 4
    s_add_u32 s65, s64, s29
    s_add_u32 m0, s64, 0
    s_add_u32 s66, s65, 16384
    buffer_load_dwordx4 v3, s[8:11], s66 offen offset:0 lds
    buffer_load_dwordx4 v3, s[8:11], s66 offen offset:1024 lds
    buffer_load_dwordx4 v3, s[8:11], s66 offen offset:2048 lds
    buffer_load_dwordx4 v3, s[8:11], s66 offen offset:3072 lds
    s_and_b32 s64, s19, 3
    s_mul_i32 s64, s64, 4096
    s_mul_i32 s65, s30, 1
    s_add_u32 s64, s64, s65
    s_add_u32 s64, s64, s29
    s_add_u32 s64, s64, 147456
    buffer_load_dwordx4 v[8:11], v3, s[8:11], s64 offen offset:0
    s_waitcnt vmcnt(9)
    s_barrier
    s_cmp_lg_u32 s22, 0
    s_cbranch_scc1 L_fo_138
    v_min_u32 v8, 47, v1
    v_lshlrev_b32 v8, 7, v8
    s_lshl_b32 s64, s18, 3
    s_and_b32 s65, s19, 1
    s_lshl_b32 s65, s65, 2
    s_add_u32 s64, s64, s65
    s_lshr_b32 s65, s30, 10
    s_add_u32 s64, s64, s65
    s_mul_i32 s64, s64, 88064
    s_lshr_b32 s65, s19, 1
    s_min_u32 s65, s65, 13
    s_mul_i32 s65, s65, 6144
    s_add_u32 s64, s64, s65
    s_add_u32 s64, s64, 12582912
    buffer_load_dword v9, v8, s[8:11], s64 offen
    s_add_u32 s64, s64, 6144
    s_cmp_lg_u32 s19, 28
    s_cbranch_scc0 .Lwh138
    s_cmp_lg_u32 s19, 29
    s_cbranch_scc1 .Lwe138
.Lwh138:
    buffer_load_dword v9, v8, s[8:11], s64 offen
.Lwe138:
L_fo_138:
    s_mul_i32 s64, s30, 4
    s_add_u32 s65, s64, s29
    s_add_u32 m0, s64, 16384
    s_add_u32 s66, s65, 32768
    buffer_load_dwordx4 v3, s[8:11], s66 offen offset:0 lds
    buffer_load_dwordx4 v3, s[8:11], s66 offen offset:1024 lds
    buffer_load_dwordx4 v3, s[8:11], s66 offen offset:2048 lds
    buffer_load_dwordx4 v3, s[8:11], s66 offen offset:3072 lds
    s_mul_i32 s64, s30, 4
    s_add_u32 s65, s64, s29
    s_add_u32 m0, s64, 32768
    s_add_u32 s66, s65, 49152
    buffer_load_dwordx4 v3, s[8:11], s66 offen offset:0 lds
    buffer_load_dwordx4 v3, s[8:11], s66 offen offset:1024 lds
    buffer_load_dwordx4 v3, s[8:11], s66 offen offset:2048 lds
    buffer_load_dwordx4 v3, s[8:11], s66 offen offset:3072 lds
    s_barrier
    s_mul_i32 s64, s30, 4
    s_add_u32 s65, s64, s29
    s_add_u32 m0, s64, 98304
    s_add_u32 s66, s65, 65536
    buffer_load_dwordx4 v3, s[8:11], s66 offen offset:0 lds
    buffer_load_dwordx4 v3, s[8:11], s66 offen offset:1024 lds
    buffer_load_dwordx4 v3, s[8:11], s66 offen offset:2048 lds
    buffer_load_dwordx4 v3, s[8:11], s66 offen offset:3072 lds
    s_mul_i32 s64, s30, 4
    s_add_u32 s65, s64, s29
    s_add_u32 m0, s64, 65536
    s_add_u32 s66, s65, 81920
    buffer_load_dwordx4 v3, s[8:11], s66 offen offset:0 lds
    buffer_load_dwordx4 v3, s[8:11], s66 offen offset:1024 lds
    buffer_load_dwordx4 v3, s[8:11], s66 offen offset:2048 lds
    buffer_load_dwordx4 v3, s[8:11], s66 offen offset:3072 lds
    s_mul_i32 s64, s30, 4
    s_add_u32 s65, s64, s29
    s_add_u32 m0, s64, 81920
    s_add_u32 s66, s65, 98304
    buffer_load_dwordx4 v3, s[8:11], s66 offen offset:0 lds
    buffer_load_dwordx4 v3, s[8:11], s66 offen offset:1024 lds
    buffer_load_dwordx4 v3, s[8:11], s66 offen offset:2048 lds
    buffer_load_dwordx4 v3, s[8:11], s66 offen offset:3072 lds
    s_mul_i32 s64, s30, 4
    s_add_u32 s65, s64, s29
    s_add_u32 m0, s64, 114688
    s_add_u32 s66, s65, 114688
    buffer_load_dwordx4 v3, s[8:11], s66 offen offset:0 lds
    buffer_load_dwordx4 v3, s[8:11], s66 offen offset:1024 lds
    buffer_load_dwordx4 v3, s[8:11], s66 offen offset:2048 lds
    buffer_load_dwordx4 v3, s[8:11], s66 offen offset:3072 lds
    s_mul_i32 s64, s30, 3
    s_add_u32 s65, s64, s29
    s_add_u32 m0, s64, 131072
    s_add_u32 s66, s65, 163840
    buffer_load_dwordx4 v3, s[8:11], s66 offen offset:0 lds
    buffer_load_dwordx4 v3, s[8:11], s66 offen offset:1024 lds
    buffer_load_dwordx4 v3, s[8:11], s66 offen offset:2048 lds
    s_branch L_lde_137
L_ldl_136:
    s_setprio 0
    s_waitcnt vmcnt(24)
    s_barrier
    s_waitcnt vmcnt(18)
    s_barrier
    s_waitcnt vmcnt(12)
    s_barrier
    s_mul_i32 s64, s30, 6
    s_add_u32 s65, s64, s28
    s_add_u32 m0, s64, 94208
    s_add_u32 s66, s65, 122880
    buffer_load_dwordx4 v3, s[8:11], s66 offen offset:0 lds
    buffer_load_dwordx4 v3, s[8:11], s66 offen offset:1024 lds
    buffer_load_dwordx4 v3, s[8:11], s66 offen offset:2048 lds
    buffer_load_dwordx4 v3, s[8:11], s66 offen offset:3072 lds
    s_add_u32 m0, s64, 98304
    s_add_u32 s66, s65, 126976
    buffer_load_dwordx4 v3, s[8:11], s66 offen offset:0 lds
    buffer_load_dwordx4 v3, s[8:11], s66 offen offset:1024 lds
    s_waitcnt vmcnt(12)
    s_barrier
    s_mul_i32 s64, s30, 6
    s_add_u32 s65, s64, s28
    s_add_u32 m0, s64, 118784
    s_add_u32 s66, s65, 147456
    buffer_load_dwordx4 v3, s[8:11], s66 offen offset:0 lds
    buffer_load_dwordx4 v3, s[8:11], s66 offen offset:1024 lds
    buffer_load_dwordx4 v3, s[8:11], s66 offen offset:2048 lds
    buffer_load_dwordx4 v3, s[8:11], s66 offen offset:3072 lds
    s_add_u32 m0, s64, 122880
    s_add_u32 s66, s65, 151552
    buffer_load_dwordx4 v3, s[8:11], s66 offen offset:0 lds
    buffer_load_dwordx4 v3, s[8:11], s66 offen offset:1024 lds
    s_mul_i32 s64, s30, 4
    s_add_u32 s65, s64, s29
    s_add_u32 m0, s64, 143360
    s_add_u32 s66, s65, 131072
    buffer_load_dwordx4 v3, s[8:11], s66 offen offset:0 lds
    buffer_load_dwordx4 v3, s[8:11], s66 offen offset:1024 lds
    buffer_load_dwordx4 v3, s[8:11], s66 offen offset:2048 lds
    buffer_load_dwordx4 v3, s[8:11], s66 offen offset:3072 lds
    s_waitcnt vmcnt(16)
    s_barrier
    s_mul_i32 s64, s30, 6
    s_add_u32 s65, s64, s28
    s_add_u32 m0, s64, 69632
    s_add_u32 s66, s65, 172032
    buffer_load_dwordx4 v3, s[8:11], s66 offen offset:0 lds
    buffer_load_dwordx4 v3, s[8:11], s66 offen offset:1024 lds
    buffer_load_dwordx4 v3, s[8:11], s66 offen offset:2048 lds
    buffer_load_dwordx4 v3, s[8:11], s66 offen offset:3072 lds
    s_add_u32 m0, s64, 73728
    s_add_u32 s66, s65, 176128
    buffer_load_dwordx4 v3, s[8:11], s66 offen offset:0 lds
    buffer_load_dwordx4 v3, s[8:11], s66 offen offset:1024 lds
    s_mul_i32 s64, s30, 4
    s_add_u32 s65, s64, s29
    s_add_u32 m0, s64, 49152
    s_add_u32 s66, s65, 0
    buffer_load_dwordx4 v3, s[8:11], s66 offen offset:0 lds
    buffer_load_dwordx4 v3, s[8:11], s66 offen offset:1024 lds
    buffer_load_dwordx4 v3, s[8:11], s66 offen offset:2048 lds
    buffer_load_dwordx4 v3, s[8:11], s66 offen offset:3072 lds
    s_waitcnt vmcnt(20)
    s_barrier
    s_mul_i32 s64, s30, 4
    s_add_u32 s65, s64, s29
    s_add_u32 m0, s64, 0
    s_add_u32 s66, s65, 16384
    buffer_load_dwordx4 v3, s[8:11], s66 offen offset:0 lds
    buffer_load_dwordx4 v3, s[8:11], s66 offen offset:1024 lds
    buffer_load_dwordx4 v3, s[8:11], s66 offen offset:2048 lds
    buffer_load_dwordx4 v3, s[8:11], s66 offen offset:3072 lds
    s_and_b32 s64, s19, 3
    s_mul_i32 s64, s64, 4096
    s_mul_i32 s65, s30, 1
    s_add_u32 s64, s64, s65
    s_add_u32 s64, s64, s29
    s_add_u32 s64, s64, 147456
    buffer_load_dwordx4 v[8:11], v3, s[8:11], s64 offen offset:0
    s_waitcnt vmcnt(9)
    s_barrier
    s_cmp_lg_u32 s22, 0
    s_cbranch_scc1 L_fo_140
    v_min_u32 v8, 47, v1
    v_lshlrev_b32 v8, 7, v8
    s_lshl_b32 s64, s18, 3
    s_and_b32 s65, s19, 1
    s_lshl_b32 s65, s65, 2
    s_add_u32 s64, s64, s65
    s_lshr_b32 s65, s30, 10
    s_add_u32 s64, s64, s65
    s_mul_i32 s64, s64, 88064
    s_lshr_b32 s65, s19, 1
    s_min_u32 s65, s65, 13
    s_mul_i32 s65, s65, 6144
    s_add_u32 s64, s64, s65
    s_add_u32 s64, s64, 12582912
    buffer_load_dword v9, v8, s[8:11], s64 offen
    s_add_u32 s64, s64, 6144
    s_cmp_lg_u32 s19, 28
    s_cbranch_scc0 .Lwh140
    s_cmp_lg_u32 s19, 29
    s_cbranch_scc1 .Lwe140
.Lwh140:
    buffer_load_dword v9, v8, s[8:11], s64 offen
.Lwe140:
L_fo_140:
    s_mul_i32 s64, s30, 4
    s_add_u32 s65, s64, s29
    s_add_u32 m0, s64, 16384
    s_add_u32 s66, s65, 32768
    buffer_load_dwordx4 v3, s[8:11], s66 offen offset:0 lds
    buffer_load_dwordx4 v3, s[8:11], s66 offen offset:1024 lds
    buffer_load_dwordx4 v3, s[8:11], s66 offen offset:2048 lds
    buffer_load_dwordx4 v3, s[8:11], s66 offen offset:3072 lds
    s_mul_i32 s64, s30, 4
    s_add_u32 s65, s64, s29
    s_add_u32 m0, s64, 32768
    s_add_u32 s66, s65, 49152
    buffer_load_dwordx4 v3, s[8:11], s66 offen offset:0 lds
    buffer_load_dwordx4 v3, s[8:11], s66 offen offset:1024 lds
    buffer_load_dwordx4 v3, s[8:11], s66 offen offset:2048 lds
    buffer_load_dwordx4 v3, s[8:11], s66 offen offset:3072 lds
    s_barrier
    s_mul_i32 s64, s30, 4
    s_add_u32 s65, s64, s29
    s_add_u32 m0, s64, 98304
    s_add_u32 s66, s65, 65536
    buffer_load_dwordx4 v3, s[8:11], s66 offen offset:0 lds
    buffer_load_dwordx4 v3, s[8:11], s66 offen offset:1024 lds
    buffer_load_dwordx4 v3, s[8:11], s66 offen offset:2048 lds
    buffer_load_dwordx4 v3, s[8:11], s66 offen offset:3072 lds
    s_mul_i32 s64, s30, 4
    s_add_u32 s65, s64, s29
    s_add_u32 m0, s64, 65536
    s_add_u32 s66, s65, 81920
    buffer_load_dwordx4 v3, s[8:11], s66 offen offset:0 lds
    buffer_load_dwordx4 v3, s[8:11], s66 offen offset:1024 lds
    buffer_load_dwordx4 v3, s[8:11], s66 offen offset:2048 lds
    buffer_load_dwordx4 v3, s[8:11], s66 offen offset:3072 lds
    s_mul_i32 s64, s30, 4
    s_add_u32 s65, s64, s29
    s_add_u32 m0, s64, 81920
    s_add_u32 s66, s65, 98304
    buffer_load_dwordx4 v3, s[8:11], s66 offen offset:0 lds
    buffer_load_dwordx4 v3, s[8:11], s66 offen offset:1024 lds
    buffer_load_dwordx4 v3, s[8:11], s66 offen offset:2048 lds
    buffer_load_dwordx4 v3, s[8:11], s66 offen offset:3072 lds
    s_mul_i32 s64, s30, 4
    s_add_u32 s65, s64, s29
    s_add_u32 m0, s64, 114688
    s_add_u32 s66, s65, 114688
    buffer_load_dwordx4 v3, s[8:11], s66 offen offset:0 lds
    buffer_load_dwordx4 v3, s[8:11], s66 offen offset:1024 lds
    buffer_load_dwordx4 v3, s[8:11], s66 offen offset:2048 lds
    buffer_load_dwordx4 v3, s[8:11], s66 offen offset:3072 lds
    s_mul_i32 s64, s30, 3
    s_add_u32 s65, s64, s29
    s_add_u32 m0, s64, 131072
    s_add_u32 s66, s65, 163840
    buffer_load_dwordx4 v3, s[8:11], s66 offen offset:0 lds
    buffer_load_dwordx4 v3, s[8:11], s66 offen offset:1024 lds
    buffer_load_dwordx4 v3, s[8:11], s66 offen offset:2048 lds
L_lde_137:
L_se_115:
    s_cmp_ge_u32 s16, 4
    s_cbranch_scc1 L_ld_142
    s_and_b32 s39, s16, 1
    s_lshr_b32 s35, s16, 1
    s_lshl_b32 s32, s18, 3
    s_and_b32 s33, s19, 3
    s_lshl_b32 s33, s33, 1
    s_add_u32 s32, s32, s33
    s_add_u32 s32, s32, s39
    s_lshr_b32 s33, s19, 2
    s_mul_i32 s34, s32, 88064
    s_mul_i32 s40, s35, 44032
    s_add_u32 s34, s34, s40
    s_add_u32 s34, s34, s3
    s_add_u32 s34, s34, 12582912
    s_lshl_b32 s36, s33, 1
    s_add_u32 s36, s36, s35
    s_lshl_b32 s37, s32, 15
    s_lshl_b32 s40, s36, 11
    s_add_u32 s37, s37, s40
    s_mul_i32 s40, s35, 3072
    s_lshl_b32 s41, s35, 10
    s_add_u32 s41, s41, 1024
    v_add_u32 v92, s40, v3
    v_add_u32 v93, s40, v4
    v_add_u32 v94, s40, v5
    v_add_u32 v95, s41, v3
    v_add_u32 v96, s41, v4
    v_add_u32 v97, s41, v5
    s_lshl_b32 s42, s16, 12
    s_xor_b32 s43, s42, 0x2000
    s_add_u32 s42, s42, 49152
    s_add_u32 s43, s43, 49152
    v_add_u32 v84, s42, v3
    v_add_u32 v85, s43, v3
    s_lshl_b32 s44, s32, 12
    s_lshr_b32 s45, s36, 2
    s_lshl_b32 s45, s45, 10
    s_add_u32 s44, s44, s45
    s_and_b32 s45, s36, 3
    s_lshl_b32 s45, s45, 2
    s_add_u32 s44, s44, s45
    s_add_u32 s44, s44, s88
    s_add_u32 s37, s37, s79
    v_lshlrev_b32 v28, 16, v236
    v_and_b32 v29, 0xffff0000, v236
    v_lshlrev_b32 v30, 16, v237
    v_and_b32 v31, 0xffff0000, v237
    v_lshlrev_b32 v32, 16, v238
    v_and_b32 v33, 0xffff0000, v238
    v_lshlrev_b32 v34, 16, v239
    v_and_b32 v35, 0xffff0000, v239
    v_lshlrev_b32 v36, 16, v240
    v_and_b32 v37, 0xffff0000, v240
    v_lshlrev_b32 v38, 16, v241
    v_and_b32 v39, 0xffff0000, v241
    v_lshlrev_b32 v40, 16, v242
    v_and_b32 v41, 0xffff0000, v242
    v_lshlrev_b32 v42, 16, v243
    v_and_b32 v43, 0xffff0000, v243
    s_cmp_lg_u32 s16, 0
    s_cbranch_scc1 L_w0_144
    s_bfe_u32 s63, s19, 0x10001
    s_lshl_b32 s63, 0x15555555, s63
    s_add_u32 s62, s25, 4
    s_mov_b32 exec_lo, s63
    s_mov_b32 exec_hi, 0
    s_mov_b32 s60, 0
    buffer_load_dwordx4 v[244:247], v254, s[8:11], s31 offen sc1
L_poll_145:
    buffer_load_dwordx4 v[248:251], v254, s[8:11], s31 offen sc1
    s_waitcnt vmcnt(1)
    v_min3_u32 v244, v244, v245, v246
    v_min_u32 v244, v244, v247
    v_cmp_gt_u32 vcc, s62, v244
    s_add_u32 s60, s60, 1
    s_cmp_gt_u32 s60, 0x4000
    s_cbranch_vccz L_polld_146
    buffer_load_dwordx4 v[244:247], v254, s[8:11], s31 offen sc1
    s_waitcnt vmcnt(1)
    v_min3_u32 v248, v248, v249, v250
    v_min_u32 v248, v248, v251
    v_cmp_gt_u32 vcc, s62, v248
    s_cbranch_scc1 L_polld_146
    s_nop 0
    s_cbranch_vccnz L_poll_145
L_polld_146:
    s_mov_b64 exec, -1
L_w0_144:
    s_barrier
    buffer_load_dwordx4 v[100:103], v3, s[8:11], s34 offen offset:0 sc1
    buffer_load_dwordx4 v[104:107], v3, s[8:11], s34 offen offset:1024 sc1
    buffer_load_dwordx4 v[108:111], v3, s[8:11], s34 offen offset:2048 sc1
    buffer_load_dwordx4 v[112:115], v3, s[8:11], s34 offen offset:3072 sc1
    s_add_u32 s34, s34, 4096
    buffer_load_dwordx4 v[116:119], v3, s[8:11], s34 offen offset:0 sc1
    buffer_load_dwordx4 v[120:123], v3, s[8:11], s34 offen offset:1024 sc1
    buffer_load_dwordx4 v[124:127], v3, s[8:11], s34 offen offset:2048 sc1
    buffer_load_dwordx4 v[128:131], v3, s[8:11], s34 offen offset:3072 sc1
    s_add_u32 s34, s34, 4096
    buffer_load_dwordx4 v[132:135], v3, s[8:11], s34 offen offset:0 sc1
    buffer_load_dwordx4 v[136:139], v3, s[8:11], s34 offen offset:1024 sc1
    buffer_load_dwordx4 v[140:143], v3, s[8:11], s34 offen offset:2048 sc1
    buffer_load_dwordx4 v[144:147], v3, s[8:11], s34 offen offset:3072 sc1
    s_add_u32 s34, s34, 4096
    ds_read_b128 v[44:47], v95 offset:49152
    ds_read_b128 v[48:51], v92 offset:49152
    ds_read_b128 v[52:55], v95 offset:53248
    ds_read_b128 v[56:59], v92 offset:53248
    ds_read_b128 v[60:63], v95 offset:57344
    ds_read_b128 v[64:67], v92 offset:57344
    s_waitcnt vmcnt(10)
    s_waitcnt lgkmcnt(4)
    v_mfma_f32_32x32x16_bf16 v[12:27], v[44:47], v[100:103], 0
    ds_read_b128 v[44:47], v95 offset:61440
    buffer_load_dwordx4 v[148:151], v3, s[8:11], s34 offen offset:0 sc1
    v_mfma_f32_32x32x16_bf16 v[28:43], v[48:51], v[100:103], v[28:43]
    ds_read_b128 v[48:51], v92 offset:61440
    s_waitcnt lgkmcnt(4)
    v_mfma_f32_32x32x16_bf16 v[12:27], v[52:55], v[104:107], v[12:27]
    ds_read_b128 v[52:55], v95 offset:0
    buffer_load_dwordx4 v[152:155], v3, s[8:11], s34 offen offset:1024 sc1
    v_mfma_f32_32x32x16_bf16 v[28:43], v[56:59], v[104:107], v[28:43]
    ds_read_b128 v[56:59], v92 offset:0
    s_waitcnt vmcnt(10)
    s_waitcnt lgkmcnt(4)
    v_mfma_f32_32x32x16_bf16 v[12:27], v[60:63], v[108:111], v[12:27]
    ds_read_b128 v[60:63], v95 offset:4096
    buffer_load_dwordx4 v[156:159], v3, s[8:11], s34 offen offset:2048 sc1
    v_mfma_f32_32x32x16_bf16 v[28:43], v[64:67], v[108:111], v[28:43]
    ds_read_b128 v[64:67], v92 offset:4096
    s_waitcnt lgkmcnt(4)
    v_mfma_f32_32x32x16_bf16 v[12:27], v[44:47], v[112:115], v[12:27]
    ds_read_b128 v[44:47], v95 offset:8192
    buffer_load_dwordx4 v[160:163], v3, s[8:11], s34 offen offset:3072 sc1
    s_add_u32 s34, s34, 4096
    v_mfma_f32_32x32x16_bf16 v[28:43], v[48:51], v[112:115], v[28:43]
    ds_read_b128 v[48:51], v92 offset:8192
    s_waitcnt vmcnt(10)
    s_waitcnt lgkmcnt(4)
    v_mfma_f32_32x32x16_bf16 v[12:27], v[52:55], v[116:119], v[12:27]
    ds_read_b128 v[52:55], v95 offset:12288
    buffer_load_dwordx4 v[164:167], v3, s[8:11], s34 offen offset:0 sc1
    v_mfma_f32_32x32x16_bf16 v[28:43], v[56:59], v[116:119], v[28:43]
    ds_read_b128 v[56:59], v92 offset:12288
    s_waitcnt lgkmcnt(4)
    v_mfma_f32_32x32x16_bf16 v[12:27], v[60:63], v[120:123], v[12:27]
    ds_read_b128 v[60:63], v95 offset:16384
    buffer_load_dwordx4 v[168:171], v3, s[8:11], s34 offen offset:1024 sc1
    v_mfma_f32_32x32x16_bf16 v[28:43], v[64:67], v[120:123], v[28:43]
    ds_read_b128 v[64:67], v92 offset:16384
    s_waitcnt vmcnt(10)
    s_waitcnt lgkmcnt(4)
    v_mfma_f32_32x32x16_bf16 v[12:27], v[44:47], v[124:127], v[12:27]
    ds_read_b128 v[44:47], v95 offset:20480
    buffer_load_dwordx4 v[172:175], v3, s[8:11], s34 offen offset:2048 sc1
    v_mfma_f32_32x32x16_bf16 v[28:43], v[48:51], v[124:127], v[28:43]
    ds_read_b128 v[48:51], v92 offset:20480
    s_waitcnt lgkmcnt(4)
    v_mfma_f32_32x32x16_bf16 v[12:27], v[52:55], v[128:131], v[12:27]
    ds_read_b128 v[52:55], v95 offset:24576
    buffer_load_dwordx4 v[176:179], v3, s[8:11], s34 offen offset:3072 sc1
    s_add_u32 s34, s34, 4096
    v_mfma_f32_32x32x16_bf16 v[28:43], v[56:59], v[128:131], v[28:43]
    ds_read_b128 v[56:59], v92 offset:24576
    s_waitcnt vmcnt(10)
    s_waitcnt lgkmcnt(4)
    v_mfma_f32_32x32x16_bf16 v[12:27], v[60:63], v[132:135], v[12:27]
    ds_read_b128 v[60:63], v95 offset:28672
    buffer_load_dwordx4 v[100:103], v3, s[8:11], s34 offen offset:0 sc1
    v_mfma_f32_32x32x16_bf16 v[28:43], v[64:67], v[132:135], v[28:43]
    ds_read_b128 v[64:67], v92 offset:28672
    s_waitcnt lgkmcnt(4)
    v_mfma_f32_32x32x16_bf16 v[12:27], v[44:47], v[136:139], v[12:27]
    s_barrier
    ds_read_b128 v[44:47], v95 offset:32768
    buffer_load_dwordx4 v[104:107], v3, s[8:11], s34 offen offset:1024 sc1
    v_mfma_f32_32x32x16_bf16 v[28:43], v[48:51], v[136:139], v[28:43]
    ds_read_b128 v[48:51], v92 offset:32768
    s_waitcnt vmcnt(10)
    s_waitcnt lgkmcnt(4)
    v_mfma_f32_32x32x16_bf16 v[12:27], v[52:55], v[140:143], v[12:27]
    ds_read_b128 v[52:55], v95 offset:36864
    buffer_load_dwordx4 v[108:111], v3, s[8:11], s34 offen offset:2048 sc1
    v_mfma_f32_32x32x16_bf16 v[28:43], v[56:59], v[140:143], v[28:43]
    ds_read_b128 v[56:59], v92 offset:36864
    s_waitcnt lgkmcnt(4)
    v_mfma_f32_32x32x16_bf16 v[12:27], v[60:63], v[144:147], v[12:27]
    ds_read_b128 v[60:63], v95 offset:40960
    buffer_load_dwordx4 v[112:115], v3, s[8:11], s34 offen offset:3072 sc1
    s_add_u32 s34, s34, 4096
    v_mfma_f32_32x32x16_bf16 v[28:43], v[64:67], v[144:147], v[28:43]
    ds_read_b128 v[64:67], v92 offset:40960
    s_waitcnt vmcnt(10)
    s_waitcnt lgkmcnt(4)
    v_mfma_f32_32x32x16_bf16 v[12:27], v[44:47], v[148:151], v[12:27]
    ds_read_b128 v[44:47], v95 offset:45056
    buffer_load_dwordx4 v[116:119], v3, s[8:11], s34 offen offset:0 sc1
    v_mfma_f32_32x32x16_bf16 v[28:43], v[48:51], v[148:151], v[28:43]
    ds_read_b128 v[48:51], v92 offset:45056
    s_waitcnt lgkmcnt(4)
    v_mfma_f32_32x32x16_bf16 v[12:27], v[52:55], v[152:155], v[12:27]
    ds_read_b128 v[52:55], v96 offset:32768
    buffer_load_dwordx4 v[120:123], v3, s[8:11], s34 offen offset:1024 sc1
    v_mfma_f32_32x32x16_bf16 v[28:43], v[56:59], v[152:155], v[28:43]
    ds_read_b128 v[56:59], v93 offset:32768
    s_waitcnt vmcnt(10)
    s_waitcnt lgkmcnt(4)
    v_mfma_f32_32x32x16_bf16 v[12:27], v[60:63], v[156:159], v[12:27]
    ds_read_b128 v[60:63], v96 offset:36864
    buffer_load_dwordx4 v[124:127], v3, s[8:11], s34 offen offset:2048 sc1
    v_mfma_f32_32x32x16_bf16 v[28:43], v[64:67], v[156:159], v[28:43]
    ds_read_b128 v[64:67], v93 offset:36864
    s_waitcnt lgkmcnt(4)
    v_mfma_f32_32x32x16_bf16 v[12:27], v[44:47], v[160:163], v[12:27]
    ds_read_b128 v[44:47], v96 offset:40960
    buffer_load_dwordx4 v[128:131], v3, s[8:11], s34 offen offset:3072 sc1
    s_add_u32 s34, s34, 4096
    v_mfma_f32_32x32x16_bf16 v[28:43], v[48:51], v[160:163], v[28:43]
    ds_read_b128 v[48:51], v93 offset:40960
    s_waitcnt vmcnt(10)
    s_waitcnt lgkmcnt(4)
    v_mfma_f32_32x32x16_bf16 v[12:27], v[52:55], v[164:167], v[12:27]
    ds_read_b128 v[52:55], v96 offset:45056
    buffer_load_dwordx4 v[132:135], v3, s[8:11], s34 offen offset:0 sc1
    v_mfma_f32_32x32x16_bf16 v[28:43], v[56:59], v[164:167], v[28:43]
    ds_read_b128 v[56:59], v93 offset:45056
    s_waitcnt lgkmcnt(4)
    v_mfma_f32_32x32x16_bf16 v[12:27], v[60:63], v[168:171], v[12:27]
    ds_read_b128 v[60:63], v96 offset:0
    buffer_load_dwordx4 v[136:139], v3, s[8:11], s34 offen offset:1024 sc1
    v_mfma_f32_32x32x16_bf16 v[28:43], v[64:67], v[168:171], v[28:43]
    ds_read_b128 v[64:67], v93 offset:0
    s_waitcnt vmcnt(10)
    s_waitcnt lgkmcnt(4)
    v_mfma_f32_32x32x16_bf16 v[12:27], v[44:47], v[172:175], v[12:27]
    ds_read_b128 v[44:47], v96 offset:4096
    buffer_load_dwordx4 v[140:143], v3, s[8:11], s34 offen offset:2048 sc1
    v_mfma_f32_32x32x16_bf16 v[28:43], v[48:51], v[172:175], v[28:43]
    ds_read_b128 v[48:51], v93 offset:4096
    s_waitcnt lgkmcnt(4)
    v_mfma_f32_32x32x16_bf16 v[12:27], v[52:55], v[176:179], v[12:27]
    ds_read_b128 v[52:55], v96 offset:8192
    buffer_load_dwordx4 v[144:147], v3, s[8:11], s34 offen offset:3072 sc1
    s_add_u32 s34, s34, 4096
    v_mfma_f32_32x32x16_bf16 v[28:43], v[56:59], v[176:179], v[28:43]
    ds_read_b128 v[56:59], v93 offset:8192
    s_waitcnt vmcnt(10)
    s_waitcnt lgkmcnt(4)
    v_mfma_f32_32x32x16_bf16 v[12:27], v[60:63], v[100:103], v[12:27]
    ds_read_b128 v[60:63], v96 offset:12288
    buffer_load_dwordx4 v[148:151], v3, s[8:11], s34 offen offset:0 sc1
    v_mfma_f32_32x32x16_bf16 v[28:43], v[64:67], v[100:103], v[28:43]
    ds_read_b128 v[64:67], v93 offset:12288
    s_waitcnt lgkmcnt(4)
    v_mfma_f32_32x32x16_bf16 v[12:27], v[44:47], v[104:107], v[12:27]
    ds_read_b128 v[44:47], v96 offset:16384
    buffer_load_dwordx4 v[152:155], v3, s[8:11], s34 offen offset:1024 sc1
    v_mfma_f32_32x32x16_bf16 v[28:43], v[48:51], v[104:107], v[28:43]
    ds_read_b128 v[48:51], v93 offset:16384
    s_waitcnt vmcnt(10)
    s_waitcnt lgkmcnt(4)
    v_mfma_f32_32x32x16_bf16 v[12:27], v[52:55], v[108:111], v[12:27]
    ds_read_b128 v[52:55], v96 offset:20480
    buffer_load_dwordx4 v[156:159], v3, s[8:11], s34 offen offset:2048 sc1
    v_mfma_f32_32x32x16_bf16 v[28:43], v[56:59], v[108:111], v[28:43]
    ds_read_b128 v[56:59], v93 offset:20480
    s_waitcnt lgkmcnt(4)
    v_mfma_f32_32x32x16_bf16 v[12:27], v[60:63], v[112:115], v[12:27]
    ds_read_b128 v[60:63], v96 offset:24576
    buffer_load_dwordx4 v[160:163], v3, s[8:11], s34 offen offset:3072 sc1
    s_add_u32 s34, s34, 4096
    v_mfma_f32_32x32x16_bf16 v[28:43], v[64:67], v[112:115], v[28:43]
    ds_read_b128 v[64:67], v93 offset:24576
    s_waitcnt vmcnt(10)
    s_waitcnt lgkmcnt(4)
    v_mfma_f32_32x32x16_bf16 v[12:27], v[44:47], v[116:119], v[12:27]
    ds_read_b128 v[44:47], v96 offset:28672
    buffer_load_dwordx4 v[164:167], v3, s[8:11], s34 offen offset:0 sc1
    v_mfma_f32_32x32x16_bf16 v[28:43], v[48:51], v[116:119], v[28:43]
    ds_read_b128 v[48:51], v93 offset:28672
    s_waitcnt lgkmcnt(4)
    v_mfma_f32_32x32x16_bf16 v[12:27], v[52:55], v[120:123], v[12:27]
    ds_read_b128 v[52:55], v96 offset:49152
    buffer_load_dwordx4 v[168:171], v3, s[8:11], s34 offen offset:1024 sc1
    v_mfma_f32_32x32x16_bf16 v[28:43], v[56:59], v[120:123], v[28:43]
    ds_read_b128 v[56:59], v93 offset:49152
    s_waitcnt vmcnt(10)
    s_waitcnt lgkmcnt(4)
    v_mfma_f32_32x32x16_bf16 v[12:27], v[60:63], v[124:127], v[12:27]
    ds_read_b128 v[60:63], v96 offset:53248
    buffer_load_dwordx4 v[172:175], v3, s[8:11], s34 offen offset:2048 sc1
    v_mfma_f32_32x32x16_bf16 v[28:43], v[64:67], v[124:127], v[28:43]
    ds_read_b128 v[64:67], v93 offset:53248
    s_waitcnt lgkmcnt(4)
    v_mfma_f32_32x32x16_bf16 v[12:27], v[44:47], v[128:131], v[12:27]
    ds_read_b128 v[44:47], v96 offset:57344
    buffer_load_dwordx4 v[176:179], v3, s[8:11], s34 offen offset:3072 sc1
    s_add_u32 s34, s34, 4096
    v_mfma_f32_32x32x16_bf16 v[28:43], v[48:51], v[128:131], v[28:43]
    ds_read_b128 v[48:51], v93 offset:57344
    s_waitcnt vmcnt(10)
    s_waitcnt lgkmcnt(4)
    v_mfma_f32_32x32x16_bf16 v[12:27], v[52:55], v[132:135], v[12:27]
    ds_read_b128 v[52:55], v96 offset:61440
    buffer_load_dwordx4 v[100:103], v3, s[8:11], s34 offen offset:0 sc1
    v_mfma_f32_32x32x16_bf16 v[28:43], v[56:59], v[132:135], v[28:43]
    ds_read_b128 v[56:59], v93 offset:61440
    s_waitcnt lgkmcnt(4)
    v_mfma_f32_32x32x16_bf16 v[12:27], v[60:63], v[136:139], v[12:27]
    ds_read_b128 v[60:63], v97 offset:12288
    buffer_load_dwordx4 v[104:107], v3, s[8:11], s34 offen offset:1024 sc1
    v_mfma_f32_32x32x16_bf16 v[28:43], v[64:67], v[136:139], v[28:43]
    ds_read_b128 v[64:67], v94 offset:12288
    s_waitcnt vmcnt(10)
    s_waitcnt lgkmcnt(4)
    v_mfma_f32_32x32x16_bf16 v[12:27], v[44:47], v[140:143], v[12:27]
    ds_read_b128 v[44:47], v97 offset:16384
    buffer_load_dwordx4 v[108:111], v3, s[8:11], s34 offen offset:2048 sc1
    v_mfma_f32_32x32x16_bf16 v[28:43], v[48:51], v[140:143], v[28:43]
    ds_read_b128 v[48:51], v94 offset:16384
    s_waitcnt lgkmcnt(4)
    v_mfma_f32_32x32x16_bf16 v[12:27], v[52:55], v[144:147], v[12:27]
    ds_read_b128 v[52:55], v97 offset:20480
    v_mfma_f32_32x32x16_bf16 v[28:43], v[56:59], v[144:147], v[28:43]
    ds_read_b128 v[56:59], v94 offset:20480
    s_waitcnt vmcnt(9)
    s_waitcnt lgkmcnt(4)
    v_mfma_f32_32x32x16_bf16 v[12:27], v[60:63], v[148:151], v[12:27]
    ds_read_b128 v[60:63], v97 offset:24576
    v_mfma_f32_32x32x16_bf16 v[28:43], v[64:67], v[148:151], v[28:43]
    ds_read_b128 v[64:67], v94 offset:24576
    s_waitcnt lgkmcnt(4)
    v_mfma_f32_32x32x16_bf16 v[12:27], v[44:47], v[152:155], v[12:27]
    s_barrier
    v_mfma_f32_32x32x16_bf16 v[28:43], v[48:51], v[152:155], v[28:43]
    s_waitcnt vmcnt(7)
    s_waitcnt lgkmcnt(2)
    v_mfma_f32_32x32x16_bf16 v[12:27], v[52:55], v[156:159], v[12:27]
    v_mfma_f32_32x32x16_bf16 v[28:43], v[56:59], v[156:159], v[28:43]
    s_waitcnt lgkmcnt(0)
    v_mfma_f32_32x32x16_bf16 v[12:27], v[60:63], v[160:163], v[12:27]
    v_mfma_f32_32x32x16_bf16 v[28:43], v[64:67], v[160:163], v[28:43]
    s_waitcnt vmcnt(5)
    v_mfma_f32_32x32x16_bf16 v[12:27], v[192:195], v[164:167], v[12:27]
    v_mfma_f32_32x32x16_bf16 v[28:43], v[196:199], v[164:167], v[28:43]
    v_mfma_f32_32x32x16_bf16 v[12:27], v[200:203], v[168:171], v[12:27]
    ds_read_b128 v[52:55], v97 offset:0
    v_mfma_f32_32x32x16_bf16 v[28:43], v[204:207], v[168:171], v[28:43]
    ds_read_b128 v[56:59], v94 offset:0
    s_waitcnt vmcnt(3)
    v_mfma_f32_32x32x16_bf16 v[12:27], v[208:211], v[172:175], v[12:27]
    ds_read_b128 v[60:63], v97 offset:4096
    v_mfma_f32_32x32x16_bf16 v[28:43], v[212:215], v[172:175], v[28:43]
    ds_read_b128 v[64:67], v94 offset:4096
    v_mfma_f32_32x32x16_bf16 v[12:27], v[216:219], v[176:179], v[12:27]
    ds_read_b128 v[44:47], v97 offset:8192
    v_mfma_f32_32x32x16_bf16 v[28:43], v[220:223], v[176:179], v[28:43]
    ds_read_b128 v[48:51], v94 offset:8192
    s_waitcnt vmcnt(1)
    s_waitcnt lgkmcnt(4)
    v_mfma_f32_32x32x16_bf16 v[12:27], v[52:55], v[100:103], v[12:27]
    v_mfma_f32_32x32x16_bf16 v[28:43], v[56:59], v[100:103], v[28:43]
    s_waitcnt lgkmcnt(2)
    v_mfma_f32_32x32x16_bf16 v[12:27], v[60:63], v[104:107], v[12:27]
    v_mfma_f32_32x32x16_bf16 v[28:43], v[64:67], v[104:107], v[28:43]
    s_waitcnt vmcnt(0)
    s_waitcnt lgkmcnt(0)
    v_mfma_f32_32x32x16_bf16 v[12:27], v[44:47], v[108:111], v[12:27]
    v_mfma_f32_32x32x16_bf16 v[28:43], v[48:51], v[108:111], v[28:43]
    s_nop 10
    ds_write_b128 v84, v[12:15] offset:0
    ds_write_b128 v84, v[16:19] offset:1024
    ds_write_b128 v84, v[20:23] offset:2048
    ds_write_b128 v84, v[24:27] offset:3072
    s_waitcnt lgkmcnt(0)
    s_barrier
    ds_read_b128 v[12:15], v85 offset:0
    ds_read_b128 v[16:19], v85 offset:1024
    ds_read_b128 v[20:23], v85 offset:2048
    ds_read_b128 v[24:27], v85 offset:3072
    s_waitcnt lgkmcnt(3)
    v_pk_add_f32 v[28:29], v[28:29], v[12:13]
    v_pk_add_f32 v[30:31], v[30:31], v[14:15]
    v_cvt_pk_bf16_f32 v236, v28, v29
    v_cvt_pk_bf16_f32 v237, v30, v31
    s_waitcnt lgkmcnt(2)
    v_pk_add_f32 v[32:33], v[32:33], v[16:17]
    v_pk_add_f32 v[34:35], v[34:35], v[18:19]
    v_cvt_pk_bf16_f32 v238, v32, v33
    v_cvt_pk_bf16_f32 v239, v34, v35
    s_waitcnt lgkmcnt(1)
    v_pk_add_f32 v[36:37], v[36:37], v[20:21]
    v_pk_add_f32 v[38:39], v[38:39], v[22:23]
    v_cvt_pk_bf16_f32 v240, v36, v37
    v_cvt_pk_bf16_f32 v241, v38, v39
    s_waitcnt lgkmcnt(0)
    v_pk_add_f32 v[40:41], v[40:41], v[24:25]
    v_pk_add_f32 v[42:43], v[42:43], v[26:27]
    v_cvt_pk_bf16_f32 v242, v40, v41
    v_cvt_pk_bf16_f32 v243, v42, v43
    s_cmp_lg_u32 s24, 0
    s_cbranch_scc1 L_pfin_147
    s_cmp_lg_u32 s22, 0
    s_cbranch_scc1 L_sts_149
    buffer_store_dwordx4 v[236:239], v3, s[8:11], s37 offen
    buffer_store_dwordx4 v[240:243], v3, s[8:11], s37 offen offset:1024
L_std_150:
    v_pk_add_f32 v[86:87], v[28:29], v[30:31]
    v_pk_mul_f32 v[88:89], v[28:29], v[28:29]
    v_pk_fma_f32 v[88:89], v[30:31], v[30:31], v[88:89]
    v_pk_add_f32 v[86:87], v[86:87], v[32:33]
    v_pk_fma_f32 v[88:89], v[32:33], v[32:33], v[88:89]
    v_pk_add_f32 v[86:87], v[86:87], v[34:35]
    v_pk_fma_f32 v[88:89], v[34:35], v[34:35], v[88:89]
    v_pk_add_f32 v[86:87], v[86:87], v[36:37]
    v_pk_fma_f32 v[88:89], v[36:37], v[36:37], v[88:89]
    v_pk_add_f32 v[86:87], v[86:87], v[38:39]
    v_pk_fma_f32 v[88:89], v[38:39], v[38:39], v[88:89]
    v_pk_add_f32 v[86:87], v[86:87], v[40:41]
    v_pk_fma_f32 v[88:89], v[40:41], v[40:41], v[88:89]
    v_pk_add_f32 v[86:87], v[86:87], v[42:43]
    v_pk_fma_f32 v[88:89], v[42:43], v[42:43], v[88:89]
    v_add_f32 v86, v86, v87
    v_add_f32 v88, v88, v89
    s_nop 1
    v_permlane32_swap_b32 v86, v88
    s_nop 1
    v_add_f32 v86, v86, v88
    s_cmp_lg_u32 s22, 0
    s_cbranch_scc1 L_sts_151
    buffer_store_dword v86, v3, s[8:11], s44 offen
L_std_152:
    s_branch L_pdn_148
L_pfin_147:
    v_and_b32 v84, 31, v1
    v_lshlrev_b32 v84, 10, v84
    v_lshrrev_b32 v85, 5, v1
    v_lshl_add_u32 v84, v85, 4, v84
    s_lshl_b32 s44, s32, 15
    s_lshl_b32 s45, s36, 6
    s_add_u32 s44, s44, s45
    v_permlane32_swap_b32 v236, v238
    v_permlane32_swap_b32 v237, v239
    v_permlane32_swap_b32 v240, v242
    v_permlane32_swap_b32 v241, v243
    buffer_store_dwordx4 v[236:239], v84, s[12:15], s44 offen
    buffer_store_dwordx4 v[240:243], v84, s[12:15], s44 offen offset:32
    s_endpgm
L_pdn_148:
    s_barrier
    s_add_u32 s61, s25, 5
    v_mov_b32 v2, s61
    s_mov_b64 exec, 1
    s_waitcnt vmcnt(0)
    s_cmp_lg_u32 s22, 0
    s_cbranch_scc1 L_sts_153
    buffer_store_dword v2, v253, s[8:11], s21 offen
L_std_154:
    s_mov_b64 exec, -1
    s_branch L_se_143
L_ld_142:
    s_cmp_lg_u32 s24, 0
    s_cbranch_scc1 L_ldl_155
    s_setprio 0
    s_waitcnt vmcnt(19)
    s_barrier
    s_waitcnt vmcnt(0)
    s_barrier
    s_barrier
    s_mul_i32 s64, s30, 3
    s_add_u32 s65, s64, s26
    s_add_u32 m0, s64, 0
    s_add_u32 s66, s65, 0
    buffer_load_dwordx4 v3, s[8:11], s66 offen offset:0 lds
    buffer_load_dwordx4 v3, s[8:11], s66 offen offset:1024 lds
    buffer_load_dwordx4 v3, s[8:11], s66 offen offset:2048 lds
    s_mul_i32 s64, s30, 3
    s_add_u32 s65, s64, s26
    s_add_u32 m0, s64, 12288
    s_add_u32 s66, s65, 12288
    buffer_load_dwordx4 v3, s[8:11], s66 offen offset:0 lds
    buffer_load_dwordx4 v3, s[8:11], s66 offen offset:1024 lds
    buffer_load_dwordx4 v3, s[8:11], s66 offen offset:2048 lds
    s_mul_i32 s64, s30, 3
    s_add_u32 s65, s64, s26
    s_add_u32 m0, s64, 24576
    s_add_u32 s66, s65, 24576
    buffer_load_dwordx4 v3, s[8:11], s66 offen offset:0 lds
    buffer_load_dwordx4 v3, s[8:11], s66 offen offset:1024 lds
    buffer_load_dwordx4 v3, s[8:11], s66 offen offset:2048 lds
    s_mul_i32 s64, s30, 3
    s_add_u32 s65, s64, s26
    s_add_u32 m0, s64, 36864
    s_add_u32 s66, s65, 36864
    buffer_load_dwordx4 v3, s[8:11], s66 offen offset:0 lds
    buffer_load_dwordx4 v3, s[8:11], s66 offen offset:1024 lds
    buffer_load_dwordx4 v3, s[8:11], s66 offen offset:2048 lds
    s_barrier
    s_barrier
    s_mul_i32 s64, s30, 3
    s_add_u32 s65, s64, s26
    s_add_u32 m0, s64, 49152
    s_add_u32 s66, s65, 49152
    buffer_load_dwordx4 v3, s[8:11], s66 offen offset:0 lds
    buffer_load_dwordx4 v3, s[8:11], s66 offen offset:1024 lds
    buffer_load_dwordx4 v3, s[8:11], s66 offen offset:2048 lds
    s_mul_i32 s64, s30, 3
    s_add_u32 s65, s64, s26
    s_add_u32 m0, s64, 61440
    s_add_u32 s66, s65, 61440
    buffer_load_dwordx4 v3, s[8:11], s66 offen offset:0 lds
    buffer_load_dwordx4 v3, s[8:11], s66 offen offset:1024 lds
    buffer_load_dwordx4 v3, s[8:11], s66 offen offset:2048 lds
    s_mul_i32 s64, s30, 3
    s_add_u32 s65, s64, s26
    s_add_u32 m0, s64, 73728
    s_add_u32 s66, s65, 73728
    buffer_load_dwordx4 v3, s[8:11], s66 offen offset:0 lds
    buffer_load_dwordx4 v3, s[8:11], s66 offen offset:1024 lds
    buffer_load_dwordx4 v3, s[8:11], s66 offen offset:2048 lds
    s_mul_i32 s64, s30, 3
    s_add_u32 s65, s64, s26
    s_add_u32 m0, s64, 86016
    s_add_u32 s66, s65, 86016
    buffer_load_dwordx4 v3, s[8:11], s66 offen offset:0 lds
    buffer_load_dwordx4 v3, s[8:11], s66 offen offset:1024 lds
    buffer_load_dwordx4 v3, s[8:11], s66 offen offset:2048 lds
    s_branch L_lde_156
L_ldl_155:
    s_setprio 0
    s_waitcnt vmcnt(19)
    s_barrier
    s_waitcnt vmcnt(0)
    s_barrier
    s_barrier
    s_barrier
    s_barrier
L_lde_156:
L_se_143:
    s_cmp_lg_u32 s24, 0
    s_cbranch_scc1 L_exit_157
    s_mov_b32 s24, 1
    s_mov_b32 s23, 20971520
    s_mul_i32 s3, s22, 20971520
    s_mul_i32 s77, s22, 65011712
    s_add_u32 s77, s77, 12582912
    s_add_u32 s25, s25, 5
    s_cmp_ge_u32 s16, 4
    s_cbranch_scc1 L_ld_158
    s_lshl_b32 s32, s18, 3
    s_and_b32 s33, s19, 1
    s_lshl_b32 s33, s33, 2
    s_add_u32 s32, s32, s33
    s_add_u32 s32, s32, s16
    s_lshr_b32 s33, s19, 1
    s_lshl_b32 s34, s32, 15
    s_add_u32 s34, s34, s79
    s_lshl_b32 s35, s32, 12
    s_add_u32 s35, s35, s88
    s_lshl_b32 s36, s33, 9
    s_mul_i32 s37, s18, 24576
    s_add_u32 s36, s36, s37
    s_add_u32 s36, s36, 46137344
    s_add_u32 s37, s36, 8192
    s_add_u32 s42, s36, 16384
    s_lshl_b32 s38, s33, 11
    s_mul_i32 s39, s32, 88064
    s_add_u32 s38, s38, s39
    s_add_u32 s38, s38, s77
    s_lshl_b32 s40, s33, 18
    s_lshl_b32 s41, s32, 11
    s_add_u32 s40, s40, s41
    s_add_u32 s40, s40, s23
    s_add_u32 s40, s40, 8388608
    s_add_u32 s41, s40, 0x20000
    v_bfe_u32 v108, v1, 4, 1
    v_lshlrev_b32 v108, 17, v108
    v_lshrrev_b32 v106, 5, v1
    v_lshl_add_u32 v108, v106, 8, v108
    v_and_b32 v106, 15, v1
    v_lshl_add_u32 v108, v106, 4, v108
    v_and_b32 v109, 31, v1
    v_lshlrev_b32 v109, 4, v109
    v_lshrrev_b32 v101, 5, v1
    v_lshl_add_u32 v109, v101, 3, v109
    s_mov_b32 s59, 0x05040100
    v_mov_b32 v91, 0
    v_mov_b32 v95, 0
    v_mov_b32 v99, 0
    v_mov_b32 v118, 0x3f803f80
    v_mov_b32 v119, 0x3f803f80
    v_mov_b32 v120, 0x3f803f80
    v_mov_b32 v121, 0x3f803f80
    s_barrier
    buffer_load_dwordx4 v[122:125], v3, s[8:11], s34 offen offset:0 sc1
    buffer_load_dwordx4 v[126:129], v3, s[8:11], s34 offen offset:1024 sc1
    buffer_load_dwordx4 v[130:133], v3, s[8:11], s34 offen offset:2048 sc1
    buffer_load_dwordx4 v[134:137], v3, s[8:11], s34 offen offset:3072 sc1
    s_add_u32 s34, s34, 4096
    buffer_load_dwordx4 v[138:141], v3, s[8:11], s34 offen offset:0 sc1
    buffer_load_dwordx4 v[142:145], v3, s[8:11], s34 offen offset:1024 sc1
    buffer_load_dwordx4 v[146:149], v3, s[8:11], s34 offen offset:2048 sc1
    buffer_load_dwordx4 v[150:153], v3, s[8:11], s34 offen offset:3072 sc1
    s_add_u32 s34, s34, 4096
    buffer_load_dwordx4 v[154:157], v3, s[8:11], s34 offen offset:0 sc1
    buffer_load_dwordx4 v[158:161], v3, s[8:11], s34 offen offset:1024 sc1
    buffer_load_dwordx4 v[72:75], v3, s[8:11], s35 offen offset:0 sc1
    buffer_load_dwordx4 v[76:79], v3, s[8:11], s35 offen offset:1024 sc1
    buffer_load_dwordx4 v[80:83], v3, s[8:11], s35 offen offset:2048 sc1
    buffer_load_dwordx4 v[84:87], v3, s[8:11], s35 offen offset:3072 sc1
    buffer_load_dwordx2 v[88:89], v109, s[8:11], s36 offen sc1
    buffer_load_dwordx2 v[92:93], v109, s[8:11], s37 offen sc1
    buffer_load_dwordx2 v[96:97], v109, s[8:11], s42 offen sc1
    ds_read_b128 v[56:59], v3 offset:1024
    ds_read_b128 v[60:63], v3 offset:2048
    ds_read_b128 v[64:67], v3 offset:4096
    ds_read_b128 v[68:71], v3 offset:5120
    s_waitcnt vmcnt(15)
    s_waitcnt lgkmcnt(2)
    v_mfma_f32_32x32x16_bf16 v[24:39], v[56:59], v[122:125], 0
    ds_read_b128 v[56:59], v3 offset:7168
    buffer_load_dwordx4 v[162:165], v3, s[8:11], s34 offen offset:2048 sc1
    v_mfma_f32_32x32x16_bf16 v[40:55], v[122:125], v[60:63], 0
    ds_read_b128 v[60:63], v3 offset:8192
    s_waitcnt lgkmcnt(2)
    v_mfma_f32_32x32x16_bf16 v[24:39], v[64:67], v[126:129], v[24:39]
    ds_read_b128 v[64:67], v3 offset:10240
    buffer_load_dwordx4 v[166:169], v3, s[8:11], s34 offen offset:3072 sc1
    s_add_u32 s34, s34, 4096
    v_mfma_f32_32x32x16_bf16 v[40:55], v[126:129], v[68:71], v[40:55]
    ds_read_b128 v[68:71], v3 offset:11264
    s_waitcnt vmcnt(15)
    s_waitcnt lgkmcnt(2)
    v_mfma_f32_32x32x16_bf16 v[24:39], v[56:59], v[130:133], v[24:39]
    ds_read_b128 v[56:59], v3 offset:13312
    buffer_load_dwordx4 v[170:173], v3, s[8:11], s34 offen offset:0 sc1
    v_mfma_f32_32x32x16_bf16 v[40:55], v[130:133], v[60:63], v[40:55]
    ds_read_b128 v[60:63], v3 offset:14336
    s_waitcnt lgkmcnt(2)
    v_mfma_f32_32x32x16_bf16 v[24:39], v[64:67], v[134:137], v[24:39]
    ds_read_b128 v[64:67], v3 offset:16384
    buffer_load_dwordx4 v[174:177], v3, s[8:11], s34 offen offset:1024 sc1
    v_mfma_f32_32x32x16_bf16 v[40:55], v[134:137], v[68:71], v[40:55]
    ds_read_b128 v[68:71], v3 offset:17408
    s_waitcnt vmcnt(15)
    s_waitcnt lgkmcnt(2)
    v_mfma_f32_32x32x16_bf16 v[24:39], v[56:59], v[138:141], v[24:39]
    ds_read_b128 v[56:59], v3 offset:19456
    buffer_load_dwordx4 v[178:181], v3, s[8:11], s34 offen offset:2048 sc1
    v_mfma_f32_32x32x16_bf16 v[40:55], v[138:141], v[60:63], v[40:55]
    ds_read_b128 v[60:63], v3 offset:20480
    s_waitcnt lgkmcnt(2)
    v_mfma_f32_32x32x16_bf16 v[24:39], v[64:67], v[142:145], v[24:39]
    ds_read_b128 v[64:67], v3 offset:22528
    buffer_load_dwordx4 v[182:185], v3, s[8:11], s34 offen offset:3072 sc1
    s_add_u32 s34, s34, 4096
    v_mfma_f32_32x32x16_bf16 v[40:55], v[142:145], v[68:71], v[40:55]
    ds_read_b128 v[68:71], v3 offset:23552
    s_waitcnt vmcnt(15)
    s_waitcnt lgkmcnt(2)
    v_mfma_f32_32x32x16_bf16 v[24:39], v[56:59], v[146:149], v[24:39]
    ds_read_b128 v[56:59], v3 offset:25600
    buffer_load_dwordx4 v[186:189], v3, s[8:11], s34 offen offset:0 sc1
    v_mfma_f32_32x32x16_bf16 v[40:55], v[146:149], v[60:63], v[40:55]
    ds_read_b128 v[60:63], v3 offset:26624
    s_waitcnt lgkmcnt(2)
    v_mfma_f32_32x32x16_bf16 v[24:39], v[64:67], v[150:153], v[24:39]
    ds_read_b128 v[64:67], v3 offset:28672
    buffer_load_dwordx4 v[190:193], v3, s[8:11], s34 offen offset:1024 sc1
    v_mfma_f32_32x32x16_bf16 v[40:55], v[150:153], v[68:71], v[40:55]
    ds_read_b128 v[68:71], v3 offset:29696
    s_waitcnt vmcnt(15)
    s_waitcnt lgkmcnt(2)
    v_mfma_f32_32x32x16_bf16 v[24:39], v[56:59], v[154:157], v[24:39]
    ds_read_b128 v[56:59], v3 offset:31744
    buffer_load_dwordx4 v[194:197], v3, s[8:11], s34 offen offset:2048 sc1
    v_mfma_f32_32x32x16_bf16 v[40:55], v[154:157], v[60:63], v[40:55]
    ds_read_b128 v[60:63], v3 offset:32768
    s_waitcnt lgkmcnt(2)
    v_mfma_f32_32x32x16_bf16 v[24:39], v[64:67], v[158:161], v[24:39]
    ds_read_b128 v[64:67], v3 offset:34816
    buffer_load_dwordx4 v[198:201], v3, s[8:11], s34 offen offset:3072 sc1
    s_add_u32 s34, s34, 4096
    v_mfma_f32_32x32x16_bf16 v[40:55], v[158:161], v[68:71], v[40:55]
    ds_read_b128 v[68:71], v3 offset:35840
    s_waitcnt vmcnt(8)
    s_waitcnt lgkmcnt(2)
    v_mfma_f32_32x32x16_bf16 v[24:39], v[56:59], v[162:165], v[24:39]
    ds_read_b128 v[56:59], v3 offset:37888
    buffer_load_dwordx4 v[202:205], v3, s[8:11], s34 offen offset:0 sc1
    v_mfma_f32_32x32x16_bf16 v[40:55], v[162:165], v[60:63], v[40:55]
    ds_read_b128 v[60:63], v3 offset:38912
    s_waitcnt lgkmcnt(2)
    v_mfma_f32_32x32x16_bf16 v[24:39], v[64:67], v[166:169], v[24:39]
    ds_read_b128 v[64:67], v3 offset:40960
    buffer_load_dwordx4 v[206:209], v3, s[8:11], s34 offen offset:1024 sc1
    v_mfma_f32_32x32x16_bf16 v[40:55], v[166:169], v[68:71], v[40:55]
    ds_read_b128 v[68:71], v3 offset:41984
    s_waitcnt vmcnt(8)
    s_waitcnt lgkmcnt(2)
    v_mfma_f32_32x32x16_bf16 v[24:39], v[56:59], v[170:173], v[24:39]
    ds_read_b128 v[56:59], v3 offset:44032
    buffer_load_dwordx4 v[210:213], v3, s[8:11], s34 offen offset:2048 sc1
    v_mfma_f32_32x32x16_bf16 v[40:55], v[170:173], v[60:63], v[40:55]
    ds_read_b128 v[60:63], v3 offset:45056
    s_waitcnt vmcnt(13)
    v_add_f32 v72, v72, v80
    v_add_f32 v73, v73, v81
    v_add_f32 v74, v74, v82
    s_waitcnt lgkmcnt(2)
    v_mfma_f32_32x32x16_bf16 v[24:39], v[64:67], v[174:177], v[24:39]
    ds_read_b128 v[64:67], v3 offset:47104
    buffer_load_dwordx4 v[214:217], v3, s[8:11], s34 offen offset:3072 sc1
    s_add_u32 s34, s34, 4096
    v_mfma_f32_32x32x16_bf16 v[40:55], v[174:177], v[68:71], v[40:55]
    ds_read_b128 v[68:71], v3 offset:48128
    v_add_f32 v75, v75, v83
    v_add_f32 v76, v76, v84
    v_add_f32 v77, v77, v85
    v_add_f32 v78, v78, v86
    s_waitcnt vmcnt(8)
    s_waitcnt lgkmcnt(2)
    v_mfma_f32_32x32x16_bf16 v[24:39], v[56:59], v[178:181], v[24:39]
    s_barrier
    ds_read_b128 v[56:59], v3 offset:50176
    buffer_load_dwordx4 v[218:221], v3, s[8:11], s34 offen offset:0 sc1
    v_mfma_f32_32x32x16_bf16 v[40:55], v[178:181], v[60:63], v[40:55]
    ds_read_b128 v[60:63], v3 offset:51200
    v_add_f32 v79, v79, v87
    v_add_f32 v72, v72, v76
    v_add_f32 v73, v73, v77
    v_add_f32 v74, v74, v78
    s_waitcnt lgkmcnt(2)
    v_mfma_f32_32x32x16_bf16 v[24:39], v[64:67], v[182:185], v[24:39]
    ds_read_b128 v[64:67], v3 offset:53248
    buffer_load_dwordx4 v[222:225], v3, s[8:11], s34 offen offset:1024 sc1
    v_mfma_f32_32x32x16_bf16 v[40:55], v[182:185], v[68:71], v[40:55]
    ds_read_b128 v[68:71], v3 offset:54272
    v_add_f32 v75, v75, v79
    v_add_f32 v72, v72, v74
    v_add_f32 v73, v73, v75
    v_add_f32 v72, v72, v73
    s_waitcnt vmcnt(8)
    s_waitcnt lgkmcnt(2)
    v_mfma_f32_32x32x16_bf16 v[24:39], v[56:59], v[186:189], v[24:39]
    ds_read_b128 v[56:59], v3 offset:56320
    buffer_load_dwordx4 v[226:229], v3, s[8:11], s34 offen offset:2048 sc1
    v_mfma_f32_32x32x16_bf16 v[40:55], v[186:189], v[60:63], v[40:55]
    ds_read_b128 v[60:63], v3 offset:57344
    v_mov_b32 v101, v72
    s_nop 1
    v_permlane32_swap_b32 v72, v101
    s_nop 1
    s_waitcnt lgkmcnt(2)
    v_mfma_f32_32x32x16_bf16 v[24:39], v[64:67], v[190:193], v[24:39]
    ds_read_b128 v[64:67], v3 offset:59392
    buffer_load_dwordx4 v[230:233], v3, s[8:11], s34 offen offset:3072 sc1
    s_add_u32 s34, s34, 4096
    v_mfma_f32_32x32x16_bf16 v[40:55], v[190:193], v[68:71], v[40:55]
    ds_read_b128 v[68:71], v3 offset:60416
    v_mul_f32 v100, 0xbb000000, v72
    v_mul_f32 v101, 0x3b000000, v101
    v_fma_f32 v101, -v100, v100, v101
    v_max_f32 v101, 0, v101
    s_waitcnt vmcnt(8)
    s_waitcnt lgkmcnt(2)
    v_mfma_f32_32x32x16_bf16 v[24:39], v[56:59], v[194:197], v[24:39]
    ds_read_b128 v[56:59], v3 offset:62464
    buffer_load_dwordx4 v[234:237], v3, s[8:11], s34 offen offset:0 sc1
    v_mfma_f32_32x32x16_bf16 v[40:55], v[194:197], v[60:63], v[40:55]
    ds_read_b128 v[60:63], v3 offset:63488
    v_add_f32 v101, 0x3727c5ac, v101
    v_rsq_f32 v102, v101
    s_nop 0
    v_cvt_pk_bf16_f32 v110, v100, v100
    s_waitcnt lgkmcnt(2)
    v_mfma_f32_32x32x16_bf16 v[24:39], v[64:67], v[198:201], v[24:39]
    ds_read_b128 v[64:67], v4 offset:0
    buffer_load_dwordx4 v[238:241], v3, s[8:11], s34 offen offset:1024 sc1
    v_mfma_f32_32x32x16_bf16 v[40:55], v[198:201], v[68:71], v[40:55]
    ds_read_b128 v[68:71], v4 offset:1024
    v_and_b32 v101, 0xffff0000, v110
    v_sub_f32 v101, v100, v101
    v_mov_b32 v111, v110
    v_cvt_pk_bf16_f32 v112, v101, v101
    s_waitcnt vmcnt(8)
    s_waitcnt lgkmcnt(2)
    v_mfma_f32_32x32x16_bf16 v[24:39], v[56:59], v[202:205], v[24:39]
    ds_read_b128 v[56:59], v4 offset:3072
    buffer_load_dwordx4 v[242:245], v3, s[8:11], s34 offen offset:2048 sc1
    v_mfma_f32_32x32x16_bf16 v[40:55], v[202:205], v[60:63], v[40:55]
    ds_read_b128 v[60:63], v4 offset:4096
    v_mov_b32 v113, 0
    v_perm_b32 v90, v89, v88, s59
    v_perm_b32 v94, v93, v92, s59
    v_perm_b32 v98, v97, v96, s59
    s_waitcnt lgkmcnt(2)
    v_mfma_f32_32x32x16_bf16 v[24:39], v[64:67], v[206:209], v[24:39]
    ds_read_b128 v[64:67], v4 offset:6144
    buffer_load_dwordx4 v[246:249], v3, s[8:11], s34 offen offset:3072 sc1
    s_add_u32 s34, s34, 4096
    v_mfma_f32_32x32x16_bf16 v[40:55], v[206:209], v[68:71], v[40:55]
    ds_read_b128 v[68:71], v4 offset:7168
    v_cmp_gt_u32 vcc, 32, v1
    v_mov_b32 v103, v102
    v_mul_f32 v104, 0x3eb8aa3b, v102
    v_cndmask_b32 v106, 0, v102, vcc
    s_waitcnt vmcnt(8)
    s_waitcnt lgkmcnt(2)
    v_mfma_f32_32x32x16_bf16 v[24:39], v[56:59], v[210:213], v[24:39]
    ds_read_b128 v[56:59], v4 offset:9216
    v_cvt_pk_bf16_f32 v114, v106, v106
    v_and_b32 v101, 0xffff0000, v114
    v_sub_f32 v101, v106, v101
    v_cvt_pk_bf16_f32 v114, v106, v101
    v_mfma_f32_32x32x16_bf16 v[40:55], v[210:213], v[60:63], v[40:55]
    ds_read_b128 v[60:63], v4 offset:10240
    v_mov_b32 v115, 0
    v_mov_b32 v116, 0
    v_mov_b32 v117, 0
    v_mov_b32 v105, v104
    s_waitcnt lgkmcnt(2)
    v_mfma_f32_32x32x16_bf16 v[24:39], v[64:67], v[214:217], v[24:39]
    ds_read_b128 v[64:67], v4 offset:12288
    s_nop 0
    v_mfma_f32_32x32x16_bf16 v[8:23], v[88:91], v[110:113], 0
    v_mfma_f32_32x32x16_bf16 v[40:55], v[214:217], v[68:71], v[40:55]
    ds_read_b128 v[68:71], v4 offset:13312
    v_mfma_f32_32x32x16_bf16 v[24:39], v[92:95], v[110:113], v[24:39]
    s_waitcnt vmcnt(6)
    s_waitcnt lgkmcnt(2)
    v_mfma_f32_32x32x16_bf16 v[24:39], v[56:59], v[218:221], v[24:39]
    ds_read_b128 v[56:59], v4 offset:15360
    v_mfma_f32_32x32x16_bf16 v[40:55], v[110:113], v[96:99], v[40:55]
    v_mfma_f32_32x32x16_bf16 v[40:55], v[218:221], v[60:63], v[40:55]
    ds_read_b128 v[60:63], v4 offset:16384
    v_mfma_f32_32x32x16_bf16 v[72:87], v[114:117], v[118:121], 0
    s_waitcnt lgkmcnt(2)
    v_mfma_f32_32x32x16_bf16 v[24:39], v[64:67], v[222:225], v[24:39]
    ds_read_b128 v[64:67], v4 offset:18432
    v_mfma_f32_32x32x16_bf16 v[40:55], v[222:225], v[68:71], v[40:55]
    ds_read_b128 v[68:71], v4 offset:19456
    s_waitcnt vmcnt(4)
    s_waitcnt lgkmcnt(2)
    v_mfma_f32_32x32x16_bf16 v[24:39], v[56:59], v[226:229], v[24:39]
    ds_read_b128 v[56:59], v4 offset:21504
    v_mfma_f32_32x32x16_bf16 v[40:55], v[226:229], v[60:63], v[40:55]
    ds_read_b128 v[60:63], v4 offset:22528
    s_waitcnt lgkmcnt(2)
    v_mfma_f32_32x32x16_bf16 v[24:39], v[64:67], v[230:233], v[24:39]
    ds_read_b128 v[64:67], v4 offset:24576
    v_mfma_f32_32x32x16_bf16 v[40:55], v[230:233], v[68:71], v[40:55]
    ds_read_b128 v[68:71], v4 offset:25600
    s_waitcnt vmcnt(2)
    s_waitcnt lgkmcnt(2)
    v_mfma_f32_32x32x16_bf16 v[24:39], v[56:59], v[234:237], v[24:39]
    ds_read_b128 v[56:59], v4 offset:27648
    v_mfma_f32_32x32x16_bf16 v[40:55], v[234:237], v[60:63], v[40:55]
    ds_read_b128 v[60:63], v4 offset:28672
    s_waitcnt lgkmcnt(2)
    v_mfma_f32_32x32x16_bf16 v[24:39], v[64:67], v[238:241], v[24:39]
    ds_read_b128 v[64:67], v4 offset:30720
    v_mfma_f32_32x32x16_bf16 v[40:55], v[238:241], v[68:71], v[40:55]
    ds_read_b128 v[68:71], v4 offset:31744
    s_waitcnt vmcnt(0)
    s_waitcnt lgkmcnt(2)
    v_mfma_f32_32x32x16_bf16 v[24:39], v[56:59], v[242:245], v[24:39]
    ds_read_b128 v[56:59], v3 offset:0
    v_mfma_f32_32x32x16_bf16 v[40:55], v[242:245], v[60:63], v[40:55]
    ds_read_b128 v[60:63], v3 offset:3072
    s_waitcnt lgkmcnt(2)
    v_mfma_f32_32x32x16_bf16 v[24:39], v[64:67], v[246:249], v[24:39]
    ds_read_b128 v[64:67], v3 offset:6144
    v_mfma_f32_32x32x16_bf16 v[40:55], v[246:249], v[68:71], v[40:55]
    ds_read_b128 v[68:71], v3 offset:9216
    s_waitcnt lgkmcnt(2)
    v_mfma_f32_32x32x16_bf16 v[8:23], v[56:59], v[122:125], v[8:23]
    ds_read_b128 v[56:59], v3 offset:12288
    v_mfma_f32_32x32x16_bf16 v[8:23], v[60:63], v[126:129], v[8:23]
    ds_read_b128 v[60:63], v3 offset:15360
    s_waitcnt lgkmcnt(2)
    v_mfma_f32_32x32x16_bf16 v[8:23], v[64:67], v[130:133], v[8:23]
    ds_read_b128 v[64:67], v3 offset:18432
    v_mfma_f32_32x32x16_bf16 v[8:23], v[68:71], v[134:137], v[8:23]
    ds_read_b128 v[68:71], v3 offset:21504
    v_mul_f32 v24, v24, v102
    v_mul_f32 v25, v25, v102
    v_mul_f32 v26, v26, v102
    v_mul_f32 v27, v27, v102
    s_waitcnt lgkmcnt(2)
    v_mfma_f32_32x32x16_bf16 v[8:23], v[56:59], v[138:141], v[8:23]
    ds_read_b128 v[56:59], v3 offset:24576
    v_mul_f32 v28, v28, v102
    v_mul_f32 v29, v29, v102
    v_mul_f32 v30, v30, v102
    v_mul_f32 v31, v31, v102
    v_mfma_f32_32x32x16_bf16 v[8:23], v[60:63], v[142:145], v[8:23]
    ds_read_b128 v[60:63], v3 offset:27648
    v_mul_f32 v32, v32, v102
    v_mul_f32 v33, v33, v102
    v_mul_f32 v34, v34, v102
    v_mul_f32 v35, v35, v102
    s_waitcnt lgkmcnt(2)
    v_mfma_f32_32x32x16_bf16 v[8:23], v[64:67], v[146:149], v[8:23]
    ds_read_b128 v[64:67], v3 offset:30720
    v_mul_f32 v36, v36, v102
    v_mul_f32 v37, v37, v102
    v_mul_f32 v38, v38, v102
    v_mul_f32 v39, v39, v102
    v_mfma_f32_32x32x16_bf16 v[8:23], v[68:71], v[150:153], v[8:23]
    ds_read_b128 v[68:71], v3 offset:33792
    v_cvt_pk_bf16_f32 v24, v24, v25
    v_cvt_pk_bf16_f32 v25, v26, v27
    v_cvt_pk_bf16_f32 v26, v28, v29
    v_cvt_pk_bf16_f32 v27, v30, v31
    s_waitcnt lgkmcnt(2)
    v_mfma_f32_32x32x16_bf16 v[8:23], v[56:59], v[154:157], v[8:23]
    ds_read_b128 v[56:59], v3 offset:36864
    v_cvt_pk_bf16_f32 v28, v32, v33
    v_cvt_pk_bf16_f32 v29, v34, v35
    v_cvt_pk_bf16_f32 v30, v36, v37
    v_cvt_pk_bf16_f32 v31, v38, v39
    v_mfma_f32_32x32x16_bf16 v[8:23], v[60:63], v[158:161], v[8:23]
    ds_read_b128 v[60:63], v3 offset:39936
    buffer_store_dwordx4 v[24:27], v3, s[8:11], s40 offen sc1
    buffer_store_dwordx4 v[28:31], v3, s[8:11], s41 offen sc1
    v_mul_f32 v40, v40, v72
    v_mul_f32 v41, v41, v73
    s_waitcnt lgkmcnt(2)
    v_mfma_f32_32x32x16_bf16 v[8:23], v[64:67], v[162:165], v[8:23]
    ds_read_b128 v[64:67], v3 offset:43008
    v_mul_f32 v42, v42, v74
    v_mul_f32 v43, v43, v75
    v_mul_f32 v44, v44, v76
    v_mul_f32 v45, v45, v77
    v_mfma_f32_32x32x16_bf16 v[8:23], v[68:71], v[166:169], v[8:23]
    ds_read_b128 v[68:71], v3 offset:46080
    v_mul_f32 v46, v46, v78
    v_mul_f32 v47, v47, v79
    v_mul_f32 v48, v48, v80
    v_mul_f32 v49, v49, v81
    s_waitcnt lgkmcnt(2)
    v_mfma_f32_32x32x16_bf16 v[8:23], v[56:59], v[170:173], v[8:23]
    ds_read_b128 v[56:59], v3 offset:49152
    v_mul_f32 v50, v50, v82
    v_mul_f32 v51, v51, v83
    v_mul_f32 v52, v52, v84
    v_mul_f32 v53, v53, v85
    v_mfma_f32_32x32x16_bf16 v[8:23], v[60:63], v[174:177], v[8:23]
    ds_read_b128 v[60:63], v3 offset:52224
    v_mul_f32 v54, v54, v86
    v_mul_f32 v55, v55, v87
    v_cvt_pk_bf16_f32 v40, v40, v41
    v_cvt_pk_bf16_f32 v41, v42, v43
    s_waitcnt lgkmcnt(2)
    v_mfma_f32_32x32x16_bf16 v[8:23], v[64:67], v[178:181], v[8:23]
    ds_read_b128 v[64:67], v3 offset:55296
    v_cvt_pk_bf16_f32 v42, v44, v45
    v_cvt_pk_bf16_f32 v43, v46, v47
    v_cvt_pk_bf16_f32 v44, v48, v49
    v_cvt_pk_bf16_f32 v45, v50, v51
    v_mfma_f32_32x32x16_bf16 v[8:23], v[68:71], v[182:185], v[8:23]
    ds_read_b128 v[68:71], v3 offset:58368
    v_cvt_pk_bf16_f32 v46, v52, v53
    v_cvt_pk_bf16_f32 v47, v54, v55
    buffer_store_dwordx4 v[40:43], v108, s[8:11], s40 offen offset:1024 sc1
    buffer_store_dwordx4 v[44:47], v108, s[8:11], s40 offen offset:1536 sc1
    s_waitcnt lgkmcnt(2)
    v_mfma_f32_32x32x16_bf16 v[8:23], v[56:59], v[186:189], v[8:23]
    ds_read_b128 v[56:59], v3 offset:61440
    v_mfma_f32_32x32x16_bf16 v[8:23], v[60:63], v[190:193], v[8:23]
    ds_read_b128 v[60:63], v3 offset:64512
    s_waitcnt lgkmcnt(2)
    v_mfma_f32_32x32x16_bf16 v[8:23], v[64:67], v[194:197], v[8:23]
    ds_read_b128 v[64:67], v4 offset:2048
    v_mfma_f32_32x32x16_bf16 v[8:23], v[68:71], v[198:201], v[8:23]
    ds_read_b128 v[68:71], v4 offset:5120
    s_waitcnt lgkmcnt(2)
    v_mfma_f32_32x32x16_bf16 v[8:23], v[56:59], v[202:205], v[8:23]
    ds_read_b128 v[56:59], v4 offset:8192
    v_mfma_f32_32x32x16_bf16 v[8:23], v[60:63], v[206:209], v[8:23]
    ds_read_b128 v[60:63], v4 offset:11264
    s_waitcnt lgkmcnt(2)
    v_mfma_f32_32x32x16_bf16 v[8:23], v[64:67], v[210:213], v[8:23]
    ds_read_b128 v[64:67], v4 offset:14336
    v_mfma_f32_32x32x16_bf16 v[8:23], v[68:71], v[214:217], v[8:23]
    ds_read_b128 v[68:71], v4 offset:17408
    s_waitcnt lgkmcnt(2)
    v_mfma_f32_32x32x16_bf16 v[8:23], v[56:59], v[218:221], v[8:23]
    ds_read_b128 v[56:59], v4 offset:20480
    v_mfma_f32_32x32x16_bf16 v[8:23], v[60:63], v[222:225], v[8:23]
    ds_read_b128 v[60:63], v4 offset:23552
    s_waitcnt lgkmcnt(2)
    v_mfma_f32_32x32x16_bf16 v[8:23], v[64:67], v[226:229], v[8:23]
    ds_read_b128 v[64:67], v4 offset:26624
    v_mfma_f32_32x32x16_bf16 v[8:23], v[68:71], v[230:233], v[8:23]
    ds_read_b128 v[68:71], v4 offset:29696
    s_waitcnt lgkmcnt(2)
    v_mfma_f32_32x32x16_bf16 v[8:23], v[56:59], v[234:237], v[8:23]
    v_mfma_f32_32x32x16_bf16 v[8:23], v[60:63], v[238:241], v[8:23]
    s_waitcnt lgkmcnt(0)
    v_mfma_f32_32x32x16_bf16 v[8:23], v[64:67], v[242:245], v[8:23]
    v_mfma_f32_32x32x16_bf16 v[8:23], v[68:71], v[246:249], v[8:23]
    s_nop 11
    v_pk_mul_f32 v[8:9], v[8:9], v[104:105]
    v_pk_mul_f32 v[10:11], v[10:11], v[104:105]
    v_pk_mul_f32 v[12:13], v[12:13], v[104:105]
    v_pk_mul_f32 v[14:15], v[14:15], v[104:105]
    v_pk_mul_f32 v[16:17], v[16:17], v[104:105]
    v_pk_mul_f32 v[18:19], v[18:19], v[104:105]
    v_pk_mul_f32 v[20:21], v[20:21], v[104:105]
    v_pk_mul_f32 v[22:23], v[22:23], v[104:105]
    v_cvt_pk_bf16_f32 v8, v8, v9
    v_cvt_pk_bf16_f32 v9, v10, v11
    v_cvt_pk_bf16_f32 v10, v12, v13
    v_cvt_pk_bf16_f32 v11, v14, v15
    v_cvt_pk_bf16_f32 v12, v16, v17
    v_cvt_pk_bf16_f32 v13, v18, v19
    v_cvt_pk_bf16_f32 v14, v20, v21
    v_cvt_pk_bf16_f32 v15, v22, v23
    s_cmp_lg_u32 s22, 0
    s_cbranch_scc1 L_sts_160
    buffer_store_dwordx4 v[8:11], v3, s[8:11], s38 offen
    buffer_store_dwordx4 v[12:15], v3, s[8:11], s38 offen offset:1024
L_std_161:
    s_add_u32 s61, s25, 1
    v_mov_b32 v2, s61
    s_mov_b64 exec, 1
    s_waitcnt vmcnt(0)
    s_cmp_lg_u32 s22, 0
    s_cbranch_scc1 L_sts_162
    buffer_store_dword v2, v253, s[8:11], s21 offen
L_std_163:
    s_mov_b64 exec, -1
    s_branch L_se_159
L_ld_158:
    s_cmp_lg_u32 s16, 7
    s_cbranch_scc1 L_w0_164
    s_and_b32 s63, s19, 1
    s_lshl_b32 s63, s63, 1
    s_lshl_b32 s63, 0x33333333, s63
    s_add_u32 s62, s25, 0
    s_mov_b32 exec_lo, s63
    s_mov_b32 exec_hi, 0
    s_mov_b32 s60, 0
    buffer_load_dwordx4 v[244:247], v254, s[8:11], s31 offen sc1
L_poll_165:
    buffer_load_dwordx4 v[248:251], v254, s[8:11], s31 offen sc1
    s_waitcnt vmcnt(1)
    v_min3_u32 v244, v244, v245, v246
    v_min_u32 v244, v244, v247
    v_cmp_gt_u32 vcc, s62, v244
    s_add_u32 s60, s60, 1
    s_cmp_gt_u32 s60, 0x4000
    s_cbranch_vccz L_polld_166
    buffer_load_dwordx4 v[244:247], v254, s[8:11], s31 offen sc1
    s_waitcnt vmcnt(1)
    v_min3_u32 v248, v248, v249, v250
    v_min_u32 v248, v248, v251
    v_cmp_gt_u32 vcc, s62, v248
    s_cbranch_scc1 L_polld_166
    s_nop 0
    s_cbranch_vccnz L_poll_165
L_polld_166:
    s_mov_b64 exec, -1
L_w0_164:
    s_setprio 0
    s_waitcnt vmcnt(12)
    s_barrier
    s_waitcnt vmcnt(0)
    s_barrier
    s_add_u32 s78, s78, 4
L_se_159:
    s_branch L_layer_25
L_exit_157:
L_end_1:
    s_endpgm
L_sts_11:
    buffer_store_dword v2, v6, s[8:11], s21 offen sc1
    s_branch L_std_12
L_sts_23:
    buffer_store_dword v2, v253, s[8:11], s21 offen sc1
    s_branch L_std_24
L_yc_31:
    s_setprio 3
    s_mov_b32 s62, 1
    s_mov_b32 exec_lo, 0xffff
    s_mov_b32 exec_hi, 0
    s_mov_b32 s60, 0
    buffer_load_dword v244, v6, s[8:11], s53 offen sc1
L_poll_33:
    buffer_load_dword v248, v6, s[8:11], s53 offen sc1
    s_waitcnt vmcnt(1)
    v_cmp_gt_u32 vcc, s62, v244
    s_add_u32 s60, s60, 1
    s_cmp_gt_u32 s60, 0x4000
    s_cbranch_vccz L_polld_34
    buffer_load_dword v244, v6, s[8:11], s53 offen sc1
    s_waitcnt vmcnt(1)
    v_cmp_gt_u32 vcc, s62, v248
    s_cbranch_scc1 L_polld_34
    s_nop 0
    s_cbranch_vccnz L_poll_33
L_polld_34:
    s_mov_b64 exec, -1
    s_mov_b32 m0, s54
    s_add_u32 s39, s55, s35
    s_add_u32 s54, s54, 16384
    s_add_u32 s55, s55, 16384
    buffer_load_dwordx4 v3, s[8:11], s39 offen offset:0 sc1 lds
    buffer_load_dwordx4 v3, s[8:11], s39 offen offset:1024 sc1 lds
    buffer_load_dwordx4 v3, s[8:11], s39 offen offset:2048 sc1 lds
    buffer_load_dwordx4 v3, s[8:11], s39 offen offset:3072 sc1 lds
    s_and_b32 s55, s55, 0x1ffff
    s_and_b32 s47, s16, 3
    s_mul_i32 s47, s47, 6912
    s_lshr_b32 s49, s16, 2
    s_lshl_b32 s49, s49, 16
    s_add_u32 s47, s47, s49
    s_add_u32 s47, s47, 65536
    v_add_u32 v228, s47, v3
    v_add_u32 v229, s47, v6
    s_sub_u32 s48, s33, 1
    s_and_b32 s48, s48, 3
    s_lshl_b32 s48, s48, 1
    s_add_u32 s48, s48, s32
    s_and_b32 s47, s48, 3
    s_mul_i32 s47, s47, 6912
    s_lshr_b32 s49, s48, 2
    s_lshl_b32 s49, s49, 16
    s_add_u32 s47, s47, s49
    s_add_u32 s47, s47, 65536
    v_add_u32 v230, s47, v3
    v_add_u32 v231, s47, v6
    s_sub_u32 s48, s33, 2
    s_and_b32 s48, s48, 3
    s_lshl_b32 s48, s48, 1
    s_add_u32 s48, s48, s32
    s_and_b32 s47, s48, 3
    s_mul_i32 s47, s47, 6912
    s_lshr_b32 s49, s48, 2
    s_lshl_b32 s49, s49, 16
    s_add_u32 s47, s47, s49
    s_add_u32 s47, s47, 65536
    v_add_u32 v232, s47, v3
    v_add_u32 v233, s47, v6
    s_sub_u32 s48, s33, 3
    s_and_b32 s48, s48, 3
    s_lshl_b32 s48, s48, 1
    s_add_u32 s48, s48, s32
    s_and_b32 s47, s48, 3
    s_mul_i32 s47, s47, 6912
    s_lshr_b32 s49, s48, 2
    s_lshl_b32 s49, s49, 16
    s_add_u32 s47, s47, s49
    s_add_u32 s47, s47, 65536
    v_add_u32 v234, s47, v3
    v_add_u32 v235, s47, v6
    s_lshl_b32 s48, s34, 15
    s_lshl_b32 s49, s19, 10
    s_add_u32 s48, s48, s49
    s_add_u32 s48, s48, s3
    s_add_u32 s48, s48, 4194304
    s_setprio 0
    s_branch L_yb_32
L_yc_38:
    s_setprio 3
    s_mov_b32 m0, s54
    s_add_u32 s39, s55, s35
    s_add_u32 s54, s54, 16384
    s_add_u32 s55, s55, 16384
    buffer_load_dwordx4 v3, s[8:11], s39 offen offset:0 sc1 lds
    buffer_load_dwordx4 v3, s[8:11], s39 offen offset:1024 sc1 lds
    buffer_load_dwordx4 v3, s[8:11], s39 offen offset:2048 sc1 lds
    buffer_load_dwordx4 v3, s[8:11], s39 offen offset:3072 sc1 lds
    s_and_b32 s55, s55, 0x1ffff
    s_mov_b32 m0, s54
    s_add_u32 s39, s55, s35
    s_add_u32 s54, s54, 16384
    s_add_u32 s55, s55, 16384
    buffer_load_dwordx4 v3, s[8:11], s39 offen offset:0 sc1 lds
    buffer_load_dwordx4 v3, s[8:11], s39 offen offset:1024 sc1 lds
    buffer_load_dwordx4 v3, s[8:11], s39 offen offset:2048 sc1 lds
    buffer_load_dwordx4 v3, s[8:11], s39 offen offset:3072 sc1 lds
    s_and_b32 s55, s55, 0x1ffff
    s_cmp_lg_u32 s24, 0
    s_cbranch_scc1 L_l0_40
    s_sub_u32 s76, s16, 0
    s_load_dwordx2 s[4:5], s[0:1], 16
    s_load_dwordx4 s[80:83], s[0:1], 32
    s_load_dwordx2 s[6:7], s[0:1], 48
    s_waitcnt lgkmcnt(0)
    s_mov_b32 s75, 0x00020000
    s_cmp_lt_u32 s2, 176
    s_cbranch_scc0 L_bo_41
    s_cmp_ge_u32 s2, 88
    s_cselect_b32 s72, s82, s80
    s_cselect_b32 s73, s83, s81
    s_cselect_b32 s60, 88, 0
    s_cselect_b32 s66, 1024, 0
    s_cselect_b32 s98, 24576, 0
    s_mov_b32 s74, 1409024
    s_sub_u32 s60, s2, s60
    s_lshr_b32 s61, s60, 2
    s_and_b32 s62, s60, 3
    s_lshl_b32 s63, s62, 3
    s_add_u32 s63, s63, s76
    s_mul_i32 s64, s63, 44032
    s_lshl_b32 s65, s61, 7
    s_add_u32 s64, s64, s65
    s_mul_i32 s65, s63, 6144
    s_add_u32 s66, s66, s65
    s_add_u32 s66, s66, 49283072
    s_lshl_b32 s67, s61, 1
    s_mul_i32 s68, s67, 43
    s_lshr_b32 s68, s68, 7
    s_mul_i32 s93, s68, 190464
    s_lshl_b32 s68, s67, 11
    s_add_u32 s93, s93, s68
    s_add_u32 s93, s93, s66
    s_add_u32 s67, s67, 1
    s_mul_i32 s68, s67, 43
    s_lshr_b32 s68, s68, 7
    s_mul_i32 s94, s68, 190464
    s_lshl_b32 s68, s67, 11
    s_add_u32 s94, s94, s68
    s_add_u32 s94, s94, s66
    s_lshl_b32 s68, s61, 10
    s_add_u32 s98, s98, s68
    s_lshl_b32 s68, s62, 7
    s_add_u32 s98, s98, s68
    s_add_u32 s98, s98, 46399488
    s_mov_b32 s95, s93
    s_mov_b32 s96, s94
    s_mov_b32 s97, 2
    s_mov_b32 s69, 2752
    s_branch L_bgo_43
L_bo_41:
    s_sub_u32 s60, s2, 176
    s_lshl_b32 s60, s60, 4
    s_lshl_b32 s61, s76, 1
    s_add_u32 s60, s60, s61
    s_min_u32 s60, s60, 942
    s_mov_b32 s97, 4
    s_mov_b32 s69, 1024
    s_cmp_lt_u32 s60, 256
    s_cbranch_scc0 L_bd_42
    s_mov_b32 s72, s4
    s_mov_b32 s73, s5
    s_mov_b32 s74, 524288
    s_lshr_b32 s61, s60, 5
    s_and_b32 s62, s60, 31
    s_add_u32 s63, s62, 1
    s_lshl_b32 s93, s61, 16
    s_and_b32 s68, s62, 15
    s_lshl_b32 s68, s68, 12
    s_add_u32 s93, s93, s68
    s_lshr_b32 s68, s62, 4
    s_lshl_b32 s68, s68, 11
    s_add_u32 s93, s93, s68
    s_add_u32 s93, s93, 48234496
    s_lshl_b32 s95, s61, 16
    s_and_b32 s68, s63, 15
    s_lshl_b32 s68, s68, 12
    s_add_u32 s95, s95, s68
    s_lshr_b32 s68, s63, 4
    s_lshl_b32 s68, s68, 11
    s_add_u32 s95, s95, s68
    s_add_u32 s95, s95, 48234496
    s_branch L_bod_44
L_bd_42:
    s_mov_b32 s72, s6
    s_mov_b32 s73, s7
    s_mov_b32 s74, 1409024
    s_sub_u32 s60, s60, 256
    s_mul_i32 s61, s60, 763
    s_lshr_b32 s61, s61, 16
    s_mul_i32 s62, s61, 86
    s_sub_u32 s62, s60, s62
    s_add_u32 s63, s62, 1
    s_mul_i32 s93, s61, 176128
    s_cmp_ge_u32 s62, 43
    s_cselect_b32 s68, 4294793216, 0
    s_add_u32 s93, s93, s68
    s_lshl_b32 s68, s62, 12
    s_add_u32 s93, s93, s68
    s_add_u32 s93, s93, 52428800
    s_mul_i32 s95, s61, 176128
    s_cmp_ge_u32 s63, 43
    s_cselect_b32 s68, 4294793216, 0
    s_add_u32 s95, s95, s68
    s_lshl_b32 s68, s63, 12
    s_add_u32 s95, s95, s68
    s_add_u32 s95, s95, 52428800
L_bod_44:
    s_lshl_b32 s64, s62, 14
    s_lshl_b32 s65, s61, 7
    s_add_u32 s64, s64, s65
    s_add_u32 s94, s93, 1024
    s_add_u32 s96, s95, 1024
L_bgo_43:
    v_lshrrev_b32 v2, 3, v1
    v_mul_lo_u32 v188, v2, s69
    v_and_b32 v2, 7, v1
    v_lshl_add_u32 v188, v2, 4, v188
    s_lshl_b32 s99, s69, 3
    s_mov_b32 s89, s64
    s_lshl_b32 s65, s76, 12
    s_add_u32 s65, s65, 98304
    v_lshrrev_b32 v2, 5, v1
    v_lshlrev_b32 v189, 9, v2
    v_bfe_u32 v2, v1, 2, 2
    v_lshl_add_u32 v189, v2, 7, v189
    v_bfe_u32 v2, v1, 4, 1
    v_lshl_add_u32 v189, v2, 5, v189
    v_and_b32 v2, 3, v1
    v_lshl_add_u32 v189, v2, 3, v189
    v_add_u32 v189, s65, v189
    s_mov_b32 m0, s65
    s_add_u32 s66, s89, s99
    buffer_load_dwordx4 v188, s[72:75], s89 offen lds
    s_add_u32 m0, s65, 1024
    s_add_u32 s64, s66, s99
    buffer_load_dwordx4 v188, s[72:75], s66 offen lds
    s_cmp_lt_u32 s2, 96
    s_cbranch_scc1 L_bq_45
    s_cmp_eq_u32 s97, 2
    s_cselect_b32 s64, s89, s64
    s_add_u32 m0, s65, 2048
    s_add_u32 s66, s64, s99
    buffer_load_dwordx4 v188, s[72:75], s64 offen lds
    s_add_u32 m0, s65, 3072
    s_nop 0
    buffer_load_dwordx4 v188, s[72:75], s66 offen lds
    s_branch L_be_46
L_bq_45:
    s_load_dwordx2 s[72:73], s[0:1], 8
    s_mov_b32 s74, 1572864
    s_lshr_b32 s61, s2, 2
    s_and_b32 s62, s2, 3
    s_lshl_b32 s62, s62, 3
    s_add_u32 s62, s62, s76
    s_mul_i32 s63, s62, 49152
    s_lshl_b32 s64, s61, 7
    s_add_u32 s63, s63, s64
    s_add_u32 s64, s63, 24576
    s_and_b32 s66, s61, 7
    s_mul_i32 s95, s66, 196608
    s_mul_i32 s66, s62, 3
    s_lshr_b32 s67, s61, 3
    s_add_u32 s66, s66, s67
    s_lshl_b32 s66, s66, 10
    s_add_u32 s95, s95, s66
    s_add_u32 s95, s95, 58720256
    s_add_u32 s96, s95, 98304
    v_lshrrev_b32 v2, 3, v1
    v_mul_u32_u24 v188, 3072, v2
    v_and_b32 v2, 7, v1
    v_lshl_add_u32 v188, v2, 4, v188
    s_add_u32 m0, s65, 2048
    s_waitcnt lgkmcnt(0)
    buffer_load_dwordx4 v188, s[72:75], s63 offen lds
    s_add_u32 m0, s65, 3072
    s_nop 0
    buffer_load_dwordx4 v188, s[72:75], s64 offen lds
L_be_46:
    s_sub_u32 s76, s16, 4
    s_load_dwordx2 s[4:5], s[0:1], 16
    s_load_dwordx4 s[80:83], s[0:1], 32
    s_load_dwordx2 s[6:7], s[0:1], 48
    s_waitcnt lgkmcnt(0)
    s_mov_b32 s75, 0x00020000
    s_cmp_lt_u32 s2, 176
    s_cbranch_scc0 L_bo_47
    s_cmp_ge_u32 s2, 88
    s_cselect_b32 s72, s82, s80
    s_cselect_b32 s73, s83, s81
    s_cselect_b32 s60, 88, 0
    s_cselect_b32 s66, 1024, 0
    s_cselect_b32 s98, 24576, 0
    s_mov_b32 s74, 1409024
    s_sub_u32 s60, s2, s60
    s_lshr_b32 s61, s60, 2
    s_and_b32 s62, s60, 3
    s_lshl_b32 s63, s62, 3
    s_add_u32 s63, s63, s76
    s_mul_i32 s64, s63, 44032
    s_lshl_b32 s65, s61, 7
    s_add_u32 s64, s64, s65
    s_mul_i32 s65, s63, 6144
    s_add_u32 s66, s66, s65
    s_add_u32 s66, s66, 49283072
    s_lshl_b32 s67, s61, 1
    s_mul_i32 s68, s67, 43
    s_lshr_b32 s68, s68, 7
    s_mul_i32 s93, s68, 190464
    s_lshl_b32 s68, s67, 11
    s_add_u32 s93, s93, s68
    s_add_u32 s93, s93, s66
    s_add_u32 s67, s67, 1
    s_mul_i32 s68, s67, 43
    s_lshr_b32 s68, s68, 7
    s_mul_i32 s94, s68, 190464
    s_lshl_b32 s68, s67, 11
    s_add_u32 s94, s94, s68
    s_add_u32 s94, s94, s66
    s_lshl_b32 s68, s61, 10
    s_add_u32 s98, s98, s68
    s_lshl_b32 s68, s62, 7
    s_add_u32 s98, s98, s68
    s_add_u32 s98, s98, 46399488
    s_mov_b32 s95, s93
    s_mov_b32 s96, s94
    s_mov_b32 s97, 2
    s_mov_b32 s69, 2752
    s_branch L_bgo_49
L_bo_47:
    s_sub_u32 s60, s2, 176
    s_lshl_b32 s60, s60, 4
    s_lshl_b32 s61, s76, 1
    s_add_u32 s60, s60, s61
    s_min_u32 s60, s60, 942
    s_mov_b32 s97, 4
    s_mov_b32 s69, 1024
    s_cmp_lt_u32 s60, 256
    s_cbranch_scc0 L_bd_48
    s_mov_b32 s72, s4
    s_mov_b32 s73, s5
    s_mov_b32 s74, 524288
    s_lshr_b32 s61, s60, 5
    s_and_b32 s62, s60, 31
    s_add_u32 s63, s62, 1
    s_lshl_b32 s93, s61, 16
    s_and_b32 s68, s62, 15
    s_lshl_b32 s68, s68, 12
    s_add_u32 s93, s93, s68
    s_lshr_b32 s68, s62, 4
    s_lshl_b32 s68, s68, 11
    s_add_u32 s93, s93, s68
    s_add_u32 s93, s93, 48234496
    s_lshl_b32 s95, s61, 16
    s_and_b32 s68, s63, 15
    s_lshl_b32 s68, s68, 12
    s_add_u32 s95, s95, s68
    s_lshr_b32 s68, s63, 4
    s_lshl_b32 s68, s68, 11
    s_add_u32 s95, s95, s68
    s_add_u32 s95, s95, 48234496
    s_branch L_bod_50
L_bd_48:
    s_mov_b32 s72, s6
    s_mov_b32 s73, s7
    s_mov_b32 s74, 1409024
    s_sub_u32 s60, s60, 256
    s_mul_i32 s61, s60, 763
    s_lshr_b32 s61, s61, 16
    s_mul_i32 s62, s61, 86
    s_sub_u32 s62, s60, s62
    s_add_u32 s63, s62, 1
    s_mul_i32 s93, s61, 176128
    s_cmp_ge_u32 s62, 43
    s_cselect_b32 s68, 4294793216, 0
    s_add_u32 s93, s93, s68
    s_lshl_b32 s68, s62, 12
    s_add_u32 s93, s93, s68
    s_add_u32 s93, s93, 52428800
    s_mul_i32 s95, s61, 176128
    s_cmp_ge_u32 s63, 43
    s_cselect_b32 s68, 4294793216, 0
    s_add_u32 s95, s95, s68
    s_lshl_b32 s68, s63, 12
    s_add_u32 s95, s95, s68
    s_add_u32 s95, s95, 52428800
L_bod_50:
    s_lshl_b32 s64, s62, 14
    s_lshl_b32 s65, s61, 7
    s_add_u32 s64, s64, s65
    s_add_u32 s94, s93, 1024
    s_add_u32 s96, s95, 1024
L_bgo_49:
    v_lshrrev_b32 v2, 3, v1
    v_mul_lo_u32 v188, v2, s69
    v_and_b32 v2, 7, v1
    v_lshl_add_u32 v188, v2, 4, v188
    s_lshl_b32 s99, s69, 3
    s_mov_b32 s89, s64
    s_lshl_b32 s65, s76, 12
    s_add_u32 s65, s65, 98304
    v_lshrrev_b32 v2, 5, v1
    v_lshlrev_b32 v189, 9, v2
    v_bfe_u32 v2, v1, 2, 2
    v_lshl_add_u32 v189, v2, 7, v189
    v_bfe_u32 v2, v1, 4, 1
    v_lshl_add_u32 v189, v2, 5, v189
    v_and_b32 v2, 3, v1
    v_lshl_add_u32 v189, v2, 3, v189
    v_add_u32 v189, s65, v189
    s_mov_b32 m0, s65
    s_add_u32 s66, s89, s99
    buffer_load_dwordx4 v188, s[72:75], s89 offen lds
    s_add_u32 m0, s65, 1024
    s_add_u32 s64, s66, s99
    buffer_load_dwordx4 v188, s[72:75], s66 offen lds
    s_cmp_lt_u32 s2, 96
    s_cbranch_scc1 L_bq_51
    s_cmp_eq_u32 s97, 2
    s_cselect_b32 s64, s89, s64
    s_add_u32 m0, s65, 2048
    s_add_u32 s66, s64, s99
    buffer_load_dwordx4 v188, s[72:75], s64 offen lds
    s_add_u32 m0, s65, 3072
    s_nop 0
    buffer_load_dwordx4 v188, s[72:75], s66 offen lds
    s_branch L_be_52
L_bq_51:
    s_load_dwordx2 s[72:73], s[0:1], 8
    s_mov_b32 s74, 1572864
    s_lshr_b32 s61, s2, 2
    s_and_b32 s62, s2, 3
    s_lshl_b32 s62, s62, 3
    s_add_u32 s62, s62, s76
    s_mul_i32 s63, s62, 49152
    s_lshl_b32 s64, s61, 7
    s_add_u32 s63, s63, s64
    s_add_u32 s64, s63, 24576
    s_and_b32 s66, s61, 7
    s_mul_i32 s95, s66, 196608
    s_mul_i32 s66, s62, 3
    s_lshr_b32 s67, s61, 3
    s_add_u32 s66, s66, s67
    s_lshl_b32 s66, s66, 10
    s_add_u32 s95, s95, s66
    s_add_u32 s95, s95, 58720256
    s_add_u32 s96, s95, 98304
    v_lshrrev_b32 v2, 3, v1
    v_mul_u32_u24 v188, 3072, v2
    v_and_b32 v2, 7, v1
    v_lshl_add_u32 v188, v2, 4, v188
    s_add_u32 m0, s65, 2048
    s_waitcnt lgkmcnt(0)
    buffer_load_dwordx4 v188, s[72:75], s63 offen lds
    s_add_u32 m0, s65, 3072
    s_nop 0
    buffer_load_dwordx4 v188, s[72:75], s64 offen lds
L_be_52:
L_l0_40:
    s_setprio 0
    s_branch L_yb_39
L_yc_55:
    s_setprio 3
    s_cmp_eq_u32 s56, 3
    s_cbranch_scc1 L_e3_57
    s_cmp_eq_u32 s56, 5
    s_cbranch_scc1 L_e5_58
    s_mov_b32 m0, s54
    s_add_u32 s39, s55, s35
    s_add_u32 s54, s54, 16384
    s_add_u32 s55, s55, 16384
    buffer_load_dwordx4 v3, s[8:11], s39 offen offset:0 sc1 lds
    buffer_load_dwordx4 v3, s[8:11], s39 offen offset:1024 sc1 lds
    buffer_load_dwordx4 v3, s[8:11], s39 offen offset:2048 sc1 lds
    buffer_load_dwordx4 v3, s[8:11], s39 offen offset:3072 sc1 lds
    s_and_b32 s55, s55, 0x1ffff
    s_mov_b32 m0, s54
    s_add_u32 s39, s55, s35
    s_add_u32 s54, s54, 16384
    s_add_u32 s55, s55, 16384
    buffer_load_dwordx4 v3, s[8:11], s39 offen offset:0 sc1 lds
    buffer_load_dwordx4 v3, s[8:11], s39 offen offset:1024 sc1 lds
    buffer_load_dwordx4 v3, s[8:11], s39 offen offset:2048 sc1 lds
    buffer_load_dwordx4 v3, s[8:11], s39 offen offset:3072 sc1 lds
    s_and_b32 s55, s55, 0x1ffff
    s_cmp_lg_u32 s24, 0
    s_cbranch_scc1 L_l0_60
    s_waitcnt vmcnt(8)
    s_sub_u32 s76, s16, 0
    s_waitcnt lgkmcnt(0)
    s_mov_b32 s75, 0x00020000
    s_cmp_lt_u32 s2, 176
    s_cbranch_scc0 L_bo_61
    s_cmp_ge_u32 s2, 88
    s_cselect_b32 s72, s82, s80
    s_cselect_b32 s73, s83, s81
    s_cselect_b32 s60, 88, 0
    s_cselect_b32 s66, 1024, 0
    s_cselect_b32 s98, 24576, 0
    s_mov_b32 s74, 1409024
    s_sub_u32 s60, s2, s60
    s_lshr_b32 s61, s60, 2
    s_and_b32 s62, s60, 3
    s_lshl_b32 s63, s62, 3
    s_add_u32 s63, s63, s76
    s_mul_i32 s64, s63, 44032
    s_lshl_b32 s65, s61, 7
    s_add_u32 s64, s64, s65
    s_mul_i32 s65, s63, 6144
    s_add_u32 s66, s66, s65
    s_add_u32 s66, s66, 49283072
    s_lshl_b32 s67, s61, 1
    s_mul_i32 s68, s67, 43
    s_lshr_b32 s68, s68, 7
    s_mul_i32 s93, s68, 190464
    s_lshl_b32 s68, s67, 11
    s_add_u32 s93, s93, s68
    s_add_u32 s93, s93, s66
    s_add_u32 s67, s67, 1
    s_mul_i32 s68, s67, 43
    s_lshr_b32 s68, s68, 7
    s_mul_i32 s94, s68, 190464
    s_lshl_b32 s68, s67, 11
    s_add_u32 s94, s94, s68
    s_add_u32 s94, s94, s66
    s_lshl_b32 s68, s61, 10
    s_add_u32 s98, s98, s68
    s_lshl_b32 s68, s62, 7
    s_add_u32 s98, s98, s68
    s_add_u32 s98, s98, 46399488
    s_mov_b32 s95, s93
    s_mov_b32 s96, s94
    s_mov_b32 s97, 2
    s_mov_b32 s69, 2752
    s_branch L_bgo_63
L_bo_61:
    s_sub_u32 s60, s2, 176
    s_lshl_b32 s60, s60, 4
    s_lshl_b32 s61, s76, 1
    s_add_u32 s60, s60, s61
    s_min_u32 s60, s60, 942
    s_mov_b32 s97, 4
    s_mov_b32 s69, 1024
    s_cmp_lt_u32 s60, 256
    s_cbranch_scc0 L_bd_62
    s_mov_b32 s72, s4
    s_mov_b32 s73, s5
    s_mov_b32 s74, 524288
    s_lshr_b32 s61, s60, 5
    s_and_b32 s62, s60, 31
    s_add_u32 s63, s62, 1
    s_lshl_b32 s93, s61, 16
    s_and_b32 s68, s62, 15
    s_lshl_b32 s68, s68, 12
    s_add_u32 s93, s93, s68
    s_lshr_b32 s68, s62, 4
    s_lshl_b32 s68, s68, 11
    s_add_u32 s93, s93, s68
    s_add_u32 s93, s93, 48234496
    s_lshl_b32 s95, s61, 16
    s_and_b32 s68, s63, 15
    s_lshl_b32 s68, s68, 12
    s_add_u32 s95, s95, s68
    s_lshr_b32 s68, s63, 4
    s_lshl_b32 s68, s68, 11
    s_add_u32 s95, s95, s68
    s_add_u32 s95, s95, 48234496
    s_branch L_bod_64
L_bd_62:
    s_mov_b32 s72, s6
    s_mov_b32 s73, s7
    s_mov_b32 s74, 1409024
    s_sub_u32 s60, s60, 256
    s_mul_i32 s61, s60, 763
    s_lshr_b32 s61, s61, 16
    s_mul_i32 s62, s61, 86
    s_sub_u32 s62, s60, s62
    s_add_u32 s63, s62, 1
    s_mul_i32 s93, s61, 176128
    s_cmp_ge_u32 s62, 43
    s_cselect_b32 s68, 4294793216, 0
    s_add_u32 s93, s93, s68
    s_lshl_b32 s68, s62, 12
    s_add_u32 s93, s93, s68
    s_add_u32 s93, s93, 52428800
    s_mul_i32 s95, s61, 176128
    s_cmp_ge_u32 s63, 43
    s_cselect_b32 s68, 4294793216, 0
    s_add_u32 s95, s95, s68
    s_lshl_b32 s68, s63, 12
    s_add_u32 s95, s95, s68
    s_add_u32 s95, s95, 52428800
L_bod_64:
    s_lshl_b32 s64, s62, 14
    s_lshl_b32 s65, s61, 7
    s_add_u32 s64, s64, s65
    s_add_u32 s94, s93, 1024
    s_add_u32 s96, s95, 1024
L_bgo_63:
    v_lshrrev_b32 v2, 3, v1
    v_mul_lo_u32 v188, v2, s69
    v_and_b32 v2, 7, v1
    v_lshl_add_u32 v188, v2, 4, v188
    s_lshl_b32 s99, s69, 3
    s_mov_b32 s89, s64
    s_lshl_b32 s65, s76, 12
    s_add_u32 s65, s65, 98304
    v_lshrrev_b32 v2, 5, v1
    v_lshlrev_b32 v189, 9, v2
    v_bfe_u32 v2, v1, 2, 2
    v_lshl_add_u32 v189, v2, 7, v189
    v_bfe_u32 v2, v1, 4, 1
    v_lshl_add_u32 v189, v2, 5, v189
    v_and_b32 v2, 3, v1
    v_lshl_add_u32 v189, v2, 3, v189
    v_add_u32 v189, s65, v189
    s_add_u32 s66, s89, s99
    s_add_u32 s64, s66, s99
    s_cmp_lt_u32 s2, 96
    s_cbranch_scc1 L_bq_65
    s_cmp_eq_u32 s97, 2
    s_cselect_b32 s64, s89, s64
    s_add_u32 s66, s64, s99
    s_nop 0
    s_branch L_be_66
L_bq_65:
    s_mov_b32 s74, 1572864
    s_lshr_b32 s61, s2, 2
    s_and_b32 s62, s2, 3
    s_lshl_b32 s62, s62, 3
    s_add_u32 s62, s62, s76
    s_mul_i32 s63, s62, 49152
    s_lshl_b32 s64, s61, 7
    s_add_u32 s63, s63, s64
    s_add_u32 s64, s63, 24576
    s_and_b32 s66, s61, 7
    s_mul_i32 s95, s66, 196608
    s_mul_i32 s66, s62, 3
    s_lshr_b32 s67, s61, 3
    s_add_u32 s66, s66, s67
    s_lshl_b32 s66, s66, 10
    s_add_u32 s95, s95, s66
    s_add_u32 s95, s95, 58720256
    s_add_u32 s96, s95, 98304
    v_lshrrev_b32 v2, 3, v1
    v_mul_u32_u24 v188, 3072, v2
    v_and_b32 v2, 7, v1
    v_lshl_add_u32 v188, v2, 4, v188
    s_waitcnt lgkmcnt(0)
    s_nop 0
L_be_66:
    ds_read_b64_tr_b16 v[192:193], v189 offset:0
    ds_read_b64_tr_b16 v[194:195], v189 offset:1024
    ds_read_b64_tr_b16 v[196:197], v189 offset:64
    ds_read_b64_tr_b16 v[198:199], v189 offset:1088
    ds_read_b64_tr_b16 v[200:201], v189 offset:2048
    ds_read_b64_tr_b16 v[202:203], v189 offset:3072
    ds_read_b64_tr_b16 v[204:205], v189 offset:2112
    ds_read_b64_tr_b16 v[206:207], v189 offset:3136
    v_mov_b32 v208, 0x3f803f80
    v_mov_b32 v209, 0x3f803f80
    v_mov_b32 v210, 0x3f803f80
    v_mov_b32 v211, 0x3f803f80
    s_lshl_b32 s60, s76, 8
    s_add_u32 s60, s60, 147456
    v_add_u32 v190, s60, v6
    s_waitcnt lgkmcnt(0)
    buffer_store_dwordx4 v[192:195], v3, s[8:11], s93 offen sc1
    buffer_store_dwordx4 v[196:199], v3, s[8:11], s94 offen sc1
    buffer_store_dwordx4 v[200:203], v3, s[8:11], s95 offen sc1
    buffer_store_dwordx4 v[204:207], v3, s[8:11], s96 offen sc1
    s_cmp_lg_u32 s97, 2
    s_cbranch_scc1 L_bx_68
    v_mfma_f32_32x32x16_bf16 v[212:227], v[208:211], v[192:195], 0
    v_mfma_f32_32x32x16_bf16 v[172:187], v[208:211], v[196:199], 0
    s_nop 15
    ds_write_b32 v190, v212
    ds_write_b32 v190, v172 offset:2048
    s_waitcnt lgkmcnt(0)
L_bx_68:
    s_sub_u32 s76, s16, 4
    s_waitcnt lgkmcnt(0)
    s_mov_b32 s75, 0x00020000
    s_cmp_lt_u32 s2, 176
    s_cbranch_scc0 L_bo_69
    s_cmp_ge_u32 s2, 88
    s_cselect_b32 s72, s82, s80
    s_cselect_b32 s73, s83, s81
    s_cselect_b32 s60, 88, 0
    s_cselect_b32 s66, 1024, 0
    s_cselect_b32 s98, 24576, 0
    s_mov_b32 s74, 1409024
    s_sub_u32 s60, s2, s60
    s_lshr_b32 s61, s60, 2
    s_and_b32 s62, s60, 3
    s_lshl_b32 s63, s62, 3
    s_add_u32 s63, s63, s76
    s_mul_i32 s64, s63, 44032
    s_lshl_b32 s65, s61, 7
    s_add_u32 s64, s64, s65
    s_mul_i32 s65, s63, 6144
    s_add_u32 s66, s66, s65
    s_add_u32 s66, s66, 49283072
    s_lshl_b32 s67, s61, 1
    s_mul_i32 s68, s67, 43
    s_lshr_b32 s68, s68, 7
    s_mul_i32 s93, s68, 190464
    s_lshl_b32 s68, s67, 11
    s_add_u32 s93, s93, s68
    s_add_u32 s93, s93, s66
    s_add_u32 s67, s67, 1
    s_mul_i32 s68, s67, 43
    s_lshr_b32 s68, s68, 7
    s_mul_i32 s94, s68, 190464
    s_lshl_b32 s68, s67, 11
    s_add_u32 s94, s94, s68
    s_add_u32 s94, s94, s66
    s_lshl_b32 s68, s61, 10
    s_add_u32 s98, s98, s68
    s_lshl_b32 s68, s62, 7
    s_add_u32 s98, s98, s68
    s_add_u32 s98, s98, 46399488
    s_mov_b32 s95, s93
    s_mov_b32 s96, s94
    s_mov_b32 s97, 2
    s_mov_b32 s69, 2752
    s_branch L_bgo_71
L_bo_69:
    s_sub_u32 s60, s2, 176
    s_lshl_b32 s60, s60, 4
    s_lshl_b32 s61, s76, 1
    s_add_u32 s60, s60, s61
    s_min_u32 s60, s60, 942
    s_mov_b32 s97, 4
    s_mov_b32 s69, 1024
    s_cmp_lt_u32 s60, 256
    s_cbranch_scc0 L_bd_70
    s_mov_b32 s72, s4
    s_mov_b32 s73, s5
    s_mov_b32 s74, 524288
    s_lshr_b32 s61, s60, 5
    s_and_b32 s62, s60, 31
    s_add_u32 s63, s62, 1
    s_lshl_b32 s93, s61, 16
    s_and_b32 s68, s62, 15
    s_lshl_b32 s68, s68, 12
    s_add_u32 s93, s93, s68
    s_lshr_b32 s68, s62, 4
    s_lshl_b32 s68, s68, 11
    s_add_u32 s93, s93, s68
    s_add_u32 s93, s93, 48234496
    s_lshl_b32 s95, s61, 16
    s_and_b32 s68, s63, 15
    s_lshl_b32 s68, s68, 12
    s_add_u32 s95, s95, s68
    s_lshr_b32 s68, s63, 4
    s_lshl_b32 s68, s68, 11
    s_add_u32 s95, s95, s68
    s_add_u32 s95, s95, 48234496
    s_branch L_bod_72
L_bd_70:
    s_mov_b32 s72, s6
    s_mov_b32 s73, s7
    s_mov_b32 s74, 1409024
    s_sub_u32 s60, s60, 256
    s_mul_i32 s61, s60, 763
    s_lshr_b32 s61, s61, 16
    s_mul_i32 s62, s61, 86
    s_sub_u32 s62, s60, s62
    s_add_u32 s63, s62, 1
    s_mul_i32 s93, s61, 176128
    s_cmp_ge_u32 s62, 43
    s_cselect_b32 s68, 4294793216, 0
    s_add_u32 s93, s93, s68
    s_lshl_b32 s68, s62, 12
    s_add_u32 s93, s93, s68
    s_add_u32 s93, s93, 52428800
    s_mul_i32 s95, s61, 176128
    s_cmp_ge_u32 s63, 43
    s_cselect_b32 s68, 4294793216, 0
    s_add_u32 s95, s95, s68
    s_lshl_b32 s68, s63, 12
    s_add_u32 s95, s95, s68
    s_add_u32 s95, s95, 52428800
L_bod_72:
    s_lshl_b32 s64, s62, 14
    s_lshl_b32 s65, s61, 7
    s_add_u32 s64, s64, s65
    s_add_u32 s94, s93, 1024
    s_add_u32 s96, s95, 1024
L_bgo_71:
    v_lshrrev_b32 v2, 3, v1
    v_mul_lo_u32 v188, v2, s69
    v_and_b32 v2, 7, v1
    v_lshl_add_u32 v188, v2, 4, v188
    s_lshl_b32 s99, s69, 3
    s_mov_b32 s89, s64
    s_lshl_b32 s65, s76, 12
    s_add_u32 s65, s65, 98304
    v_lshrrev_b32 v2, 5, v1
    v_lshlrev_b32 v189, 9, v2
    v_bfe_u32 v2, v1, 2, 2
    v_lshl_add_u32 v189, v2, 7, v189
    v_bfe_u32 v2, v1, 4, 1
    v_lshl_add_u32 v189, v2, 5, v189
    v_and_b32 v2, 3, v1
    v_lshl_add_u32 v189, v2, 3, v189
    v_add_u32 v189, s65, v189
    s_add_u32 s66, s89, s99
    s_add_u32 s64, s66, s99
    s_cmp_lt_u32 s2, 96
    s_cbranch_scc1 L_bq_73
    s_cmp_eq_u32 s97, 2
    s_cselect_b32 s64, s89, s64
    s_add_u32 s66, s64, s99
    s_nop 0
    s_branch L_be_74
L_bq_73:
    s_mov_b32 s74, 1572864
    s_lshr_b32 s61, s2, 2
    s_and_b32 s62, s2, 3
    s_lshl_b32 s62, s62, 3
    s_add_u32 s62, s62, s76
    s_mul_i32 s63, s62, 49152
    s_lshl_b32 s64, s61, 7
    s_add_u32 s63, s63, s64
    s_add_u32 s64, s63, 24576
    s_and_b32 s66, s61, 7
    s_mul_i32 s95, s66, 196608
    s_mul_i32 s66, s62, 3
    s_lshr_b32 s67, s61, 3
    s_add_u32 s66, s66, s67
    s_lshl_b32 s66, s66, 10
    s_add_u32 s95, s95, s66
    s_add_u32 s95, s95, 58720256
    s_add_u32 s96, s95, 98304
    v_lshrrev_b32 v2, 3, v1
    v_mul_u32_u24 v188, 3072, v2
    v_and_b32 v2, 7, v1
    v_lshl_add_u32 v188, v2, 4, v188
    s_waitcnt lgkmcnt(0)
    s_nop 0
L_be_74:
    ds_read_b64_tr_b16 v[192:193], v189 offset:0
    ds_read_b64_tr_b16 v[194:195], v189 offset:1024
    ds_read_b64_tr_b16 v[196:197], v189 offset:64
    ds_read_b64_tr_b16 v[198:199], v189 offset:1088
    ds_read_b64_tr_b16 v[200:201], v189 offset:2048
    ds_read_b64_tr_b16 v[202:203], v189 offset:3072
    ds_read_b64_tr_b16 v[204:205], v189 offset:2112
    ds_read_b64_tr_b16 v[206:207], v189 offset:3136
    v_mov_b32 v208, 0x3f803f80
    v_mov_b32 v209, 0x3f803f80
    v_mov_b32 v210, 0x3f803f80
    v_mov_b32 v211, 0x3f803f80
    s_lshl_b32 s60, s76, 8
    s_add_u32 s60, s60, 147456
    v_add_u32 v190, s60, v6
    s_waitcnt lgkmcnt(0)
    buffer_store_dwordx4 v[192:195], v3, s[8:11], s93 offen sc1
    buffer_store_dwordx4 v[196:199], v3, s[8:11], s94 offen sc1
    buffer_store_dwordx4 v[200:203], v3, s[8:11], s95 offen sc1
    buffer_store_dwordx4 v[204:207], v3, s[8:11], s96 offen sc1
    s_cmp_lg_u32 s97, 2
    s_cbranch_scc1 L_bx_76
    v_mfma_f32_32x32x16_bf16 v[212:227], v[208:211], v[192:195], 0
    v_mfma_f32_32x32x16_bf16 v[172:187], v[208:211], v[196:199], 0
    s_nop 15
    ds_write_b32 v190, v212
    ds_write_b32 v190, v172 offset:2048
    s_waitcnt lgkmcnt(0)
L_bx_76:
L_l0_60:
    s_branch L_ee_59
L_e3_57:
    s_cmp_lg_u32 s24, 0
    s_cbranch_scc1 L_l0_77
    v_mov_b32 v2, 1
    s_mov_b64 exec, 1
    ds_add_rtn_u32 v2, v0, v2 offset:4
    s_mov_b32 s61, 3
    s_waitcnt lgkmcnt(0)
    v_readfirstlane_b32 s62, v2
    s_mov_b64 exec, -1
    s_cmp_lg_u32 s61, s62
    s_cbranch_scc1 L_arr_78
    s_cmp_lg_u32 s97, 2
    s_cbranch_scc1 L_br_79
    v_add_u32 v190, 147456, v6
    s_add_u32 s67, s98, 0
    ds_read_b32 v212, v190 offset:0
    ds_read_b32 v213, v190 offset:256
    ds_read_b32 v214, v190 offset:512
    ds_read_b32 v215, v190 offset:768
    ds_read_b32 v216, v190 offset:1024
    ds_read_b32 v217, v190 offset:1280
    ds_read_b32 v218, v190 offset:1536
    ds_read_b32 v219, v190 offset:1792
    s_waitcnt lgkmcnt(0)
    v_add_f32 v212, v212, v216
    v_add_f32 v213, v213, v217
    v_add_f32 v214, v214, v218
    v_add_f32 v215, v215, v219
    v_add_f32 v212, v212, v214
    v_add_f32 v213, v213, v215
    v_add_f32 v212, v212, v213
    v_cvt_pk_bf16_f32 v220, v212, v212
    v_and_b32 v221, 0xffff0000, v220
    v_sub_f32 v221, v212, v221
    v_cvt_pk_bf16_f32 v220, v212, v221
    s_mov_b32 exec_lo, -1
    s_mov_b32 exec_hi, 0
    buffer_store_dword v220, v6, s[8:11], s67 offen sc1
    s_mov_b64 exec, -1
    v_add_u32 v190, 149504, v6
    s_add_u32 s67, s98, 512
    ds_read_b32 v212, v190 offset:0
    ds_read_b32 v213, v190 offset:256
    ds_read_b32 v214, v190 offset:512
    ds_read_b32 v215, v190 offset:768
    ds_read_b32 v216, v190 offset:1024
    ds_read_b32 v217, v190 offset:1280
    ds_read_b32 v218, v190 offset:1536
    ds_read_b32 v219, v190 offset:1792
    s_waitcnt lgkmcnt(0)
    v_add_f32 v212, v212, v216
    v_add_f32 v213, v213, v217
    v_add_f32 v214, v214, v218
    v_add_f32 v215, v215, v219
    v_add_f32 v212, v212, v214
    v_add_f32 v213, v213, v215
    v_add_f32 v212, v212, v213
    v_cvt_pk_bf16_f32 v220, v212, v212
    v_and_b32 v221, 0xffff0000, v220
    v_sub_f32 v221, v212, v221
    v_cvt_pk_bf16_f32 v220, v212, v221
    s_mov_b32 exec_lo, -1
    s_mov_b32 exec_hi, 0
    buffer_store_dword v220, v6, s[8:11], s67 offen sc1
    s_mov_b64 exec, -1
    s_waitcnt vmcnt(0)
L_br_79:
    s_lshl_b32 s61, s2, 2
    s_add_u32 s61, s61, 54603776
    v_mov_b32 v2, 1
    s_mov_b64 exec, 1
    buffer_store_dword v2, v7, s[8:11], s61 offen sc1
    s_mov_b64 exec, -1
L_arr_78:
L_l0_77:
    s_mov_b32 m0, s54
    s_add_u32 s39, s55, s35
    s_add_u32 s54, s54, 16384
    s_add_u32 s55, s55, 16384
    buffer_load_dwordx4 v3, s[8:11], s39 offen offset:0 sc1 lds
    buffer_load_dwordx4 v3, s[8:11], s39 offen offset:1024 sc1 lds
    buffer_load_dwordx4 v3, s[8:11], s39 offen offset:2048 sc1 lds
    buffer_load_dwordx4 v3, s[8:11], s39 offen offset:3072 sc1 lds
    s_and_b32 s55, s55, 0x1ffff
    s_mov_b32 m0, s54
    s_add_u32 s39, s55, s35
    s_add_u32 s54, s54, 16384
    s_add_u32 s55, s55, 16384
    buffer_load_dwordx4 v3, s[8:11], s39 offen offset:0 sc1 lds
    buffer_load_dwordx4 v3, s[8:11], s39 offen offset:1024 sc1 lds
    buffer_load_dwordx4 v3, s[8:11], s39 offen offset:2048 sc1 lds
    buffer_load_dwordx4 v3, s[8:11], s39 offen offset:3072 sc1 lds
    s_and_b32 s55, s55, 0x1ffff
    s_cmp_eq_u32 s24, 0
    s_cbranch_scc1 L_l1_80
    s_mul_i32 s64, s30, 4
    s_add_u32 s65, s64, s27
    s_add_u32 m0, s64, 0
    s_add_u32 s66, s65, 0
    buffer_load_dwordx4 v3, s[8:11], s66 offen offset:0 lds
    buffer_load_dwordx4 v3, s[8:11], s66 offen offset:1024 lds
    buffer_load_dwordx4 v3, s[8:11], s66 offen offset:2048 lds
    buffer_load_dwordx4 v3, s[8:11], s66 offen offset:3072 lds
    s_mul_i32 s64, s30, 4
    s_add_u32 s65, s64, s27
    s_add_u32 m0, s64, 16384
    s_add_u32 s66, s65, 16384
    buffer_load_dwordx4 v3, s[8:11], s66 offen offset:0 lds
    buffer_load_dwordx4 v3, s[8:11], s66 offen offset:1024 lds
    buffer_load_dwordx4 v3, s[8:11], s66 offen offset:2048 lds
    buffer_load_dwordx4 v3, s[8:11], s66 offen offset:3072 lds
    s_mul_i32 s64, s30, 4
    s_add_u32 s65, s64, s27
    s_add_u32 m0, s64, 32768
    s_add_u32 s66, s65, 32768
    buffer_load_dwordx4 v3, s[8:11], s66 offen offset:0 lds
    buffer_load_dwordx4 v3, s[8:11], s66 offen offset:1024 lds
    buffer_load_dwordx4 v3, s[8:11], s66 offen offset:2048 lds
    buffer_load_dwordx4 v3, s[8:11], s66 offen offset:3072 lds
    s_mul_i32 s64, s30, 4
    s_add_u32 s65, s64, s27
    s_add_u32 m0, s64, 49152
    s_add_u32 s66, s65, 49152
    buffer_load_dwordx4 v3, s[8:11], s66 offen offset:0 lds
    buffer_load_dwordx4 v3, s[8:11], s66 offen offset:1024 lds
    buffer_load_dwordx4 v3, s[8:11], s66 offen offset:2048 lds
    buffer_load_dwordx4 v3, s[8:11], s66 offen offset:3072 lds
L_l1_80:
    s_cmp_lg_u32 s24, 0
    s_cbranch_scc1 L_l0_81
    s_cmp_lg_u32 s22, 0
    s_cbranch_scc1 L_fo_82
    s_lshr_b32 s60, s30, 10
    s_lshl_b32 s61, s18, 3
    s_lshl_b32 s62, s60, 1
    s_add_u32 s62, s62, s61
    s_lshl_b32 s62, s62, 15
    s_lshl_b32 s63, s19, 10
    s_add_u32 s62, s62, s63
    s_add_u32 s62, s62, 4194304
    buffer_store_dwordx4 v[168:171], v3, s[8:11], s62 offen sc1
    s_add_u32 s62, s62, 32768
    buffer_store_dwordx4 v[168:171], v3, s[8:11], s62 offen sc1
    s_and_b32 s62, s19, 3
    s_lshl_b32 s62, s62, 1
    s_add_u32 s62, s62, s61
    s_and_b32 s63, s60, 1
    s_add_u32 s62, s62, s63
    s_lshr_b32 s63, s19, 2
    s_lshl_b32 s63, s63, 1
    s_lshr_b32 s64, s60, 1
    s_add_u32 s63, s63, s64
    s_lshl_b32 s64, s62, 15
    s_lshl_b32 s65, s63, 11
    s_add_u32 s64, s64, s65
    s_add_u32 s64, s64, 2097152
    buffer_store_dwordx4 v[168:171], v3, s[8:11], s64 offen sc1
    buffer_store_dwordx4 v[168:171], v3, s[8:11], s64 offen offset:1024 sc1
    s_lshl_b32 s64, s62, 12
    s_lshr_b32 s65, s63, 2
    s_lshl_b32 s65, s65, 10
    s_add_u32 s64, s64, s65
    s_add_u32 s64, s64, 19136512
    buffer_store_dwordx4 v[168:171], v3, s[8:11], s64 offen sc1
    s_and_b32 s62, s19, 1
    s_lshl_b32 s62, s62, 2
    s_add_u32 s62, s62, s61
    s_add_u32 s62, s62, s60
    s_mul_i32 s62, s62, 88064
    s_lshr_b32 s63, s19, 1
    s_mul_i32 s63, s63, 6144
    s_min_u32 s63, s63, 81920
    s_add_u32 s62, s62, s63
    s_add_u32 s62, s62, 12582912
    s_add_u32 s63, s62, 4096
    buffer_store_dwordx4 v[168:171], v3, s[8:11], s62 offen offset:0 sc1
    buffer_store_dwordx4 v[168:171], v3, s[8:11], s62 offen offset:1024 sc1
    buffer_store_dwordx4 v[168:171], v3, s[8:11], s62 offen offset:2048 sc1
    buffer_store_dwordx4 v[168:171], v3, s[8:11], s62 offen offset:3072 sc1
    buffer_store_dwordx4 v[168:171], v3, s[8:11], s63 offen offset:0 sc1
    buffer_store_dwordx4 v[168:171], v3, s[8:11], s63 offen offset:1024 sc1
L_fo_82:
L_l0_81:
    s_branch L_ee_59
L_e5_58:
    s_cmp_lg_u32 s24, 0
    s_cbranch_scc1 L_l0_83
    s_getpc_b64 s[60:61]
L_pc_84:
    s_sub_u32 s60, s60, L_pc_84 - L_wo_start
    s_subb_u32 s61, s61, 0
    s_lshl_b32 s62, s19, 2
    s_lshr_b32 s63, s30, 10
    s_add_u32 s62, s62, s63
    s_lshl_b32 s62, s62, 8
    s_min_u32 s62, s62, L_code_end - L_wo_start - 256
    v_add_u32 v166, s62, v6
    global_load_dword v165, v166, s[60:61]
L_l0_83:
    s_cmp_lg_u32 s24, 0
    s_cbranch_scc1 L_l0_85
    s_mov_b32 s61, 54603776
    s_mov_b32 s60, 0
L_bgp_86:
    buffer_load_dwordx4 v[168:171], v3, s[8:11], s61 offen sc1
    s_add_u32 s60, s60, 1
    s_waitcnt vmcnt(0)
    v_and_b32 v168, v168, v169
    v_and_b32 v170, v170, v171
    v_and_b32 v168, v168, v170
    v_cmp_ne_u32 vcc, 1, v168
    s_cmp_gt_u32 s60, 0x4000
    s_cbranch_scc1 L_bgd_87
    s_cbranch_vccnz L_bgp_86
L_bgd_87:
    s_mul_i32 s64, s30, 4
    s_add_u32 s65, s64, s27
    s_add_u32 m0, s64, 0
    s_add_u32 s66, s65, 0
    buffer_load_dwordx4 v3, s[8:11], s66 offen offset:0 lds
    buffer_load_dwordx4 v3, s[8:11], s66 offen offset:1024 lds
    buffer_load_dwordx4 v3, s[8:11], s66 offen offset:2048 lds
    buffer_load_dwordx4 v3, s[8:11], s66 offen offset:3072 lds
    s_mul_i32 s64, s30, 4
    s_add_u32 s65, s64, s27
    s_add_u32 m0, s64, 16384
    s_add_u32 s66, s65, 16384
    buffer_load_dwordx4 v3, s[8:11], s66 offen offset:0 lds
    buffer_load_dwordx4 v3, s[8:11], s66 offen offset:1024 lds
    buffer_load_dwordx4 v3, s[8:11], s66 offen offset:2048 lds
    buffer_load_dwordx4 v3, s[8:11], s66 offen offset:3072 lds
    s_mul_i32 s64, s30, 4
    s_add_u32 s65, s64, s27
    s_add_u32 m0, s64, 32768
    s_add_u32 s66, s65, 32768
    buffer_load_dwordx4 v3, s[8:11], s66 offen offset:0 lds
    buffer_load_dwordx4 v3, s[8:11], s66 offen offset:1024 lds
    buffer_load_dwordx4 v3, s[8:11], s66 offen offset:2048 lds
    buffer_load_dwordx4 v3, s[8:11], s66 offen offset:3072 lds
    s_mul_i32 s64, s30, 4
    s_add_u32 s65, s64, s27
    s_add_u32 m0, s64, 49152
    s_add_u32 s66, s65, 49152
    buffer_load_dwordx4 v3, s[8:11], s66 offen offset:0 lds
    buffer_load_dwordx4 v3, s[8:11], s66 offen offset:1024 lds
    buffer_load_dwordx4 v3, s[8:11], s66 offen offset:2048 lds
    buffer_load_dwordx4 v3, s[8:11], s66 offen offset:3072 lds
L_l0_85:
    v_lshlrev_b32 v164, 7, v1
    s_and_b32 s64, s19, 1
    s_mul_i32 s64, s64, 98304
    s_add_u32 s64, s64, s28
    s_mul_i32 s65, s30, 24
    s_add_u32 s64, s64, s65
    s_add_u32 s65, s64, 8192
    s_add_u32 s66, s64, 16384
    buffer_load_dword v165, v164, s[8:11], s64 offen
    buffer_load_dword v165, v164, s[8:11], s65 offen
    buffer_load_dword v165, v164, s[8:11], s66 offen
L_ee_59:
    s_setprio 0
    s_branch L_yb_56
L_sts_90:
    buffer_store_dwordx4 v[80:83], v3, s[8:11], s48 offen sc1
    s_branch L_std_91
L_sts_95:
    buffer_store_dwordx4 v[80:83], v3, s[8:11], s48 offen sc1
    s_branch L_std_96
L_sts_97:
    buffer_store_dword v2, v7, s[8:11], s62 offen sc1
    s_branch L_std_98
L_sts_105:
    buffer_store_dwordx4 v[236:239], v3, s[8:11], s37 offen sc1
    buffer_store_dwordx4 v[240:243], v3, s[8:11], s37 offen offset:1024 sc1
    s_branch L_std_106
L_sts_107:
    buffer_store_dword v86, v3, s[8:11], s44 offen sc1
    s_branch L_std_108
L_sts_109:
    buffer_store_dword v2, v253, s[8:11], s21 offen sc1
    s_branch L_std_110
L_sts_120:
    buffer_store_dwordx4 v[8:11], v3, s[8:11], s39 offen sc1
    buffer_store_dwordx4 v[12:15], v3, s[8:11], s39 offen offset:1024 sc1
    s_branch L_std_121
L_sts_123:
    buffer_store_dwordx4 v[40:43], v3, s[8:11], s39 offen sc1
    buffer_store_dwordx4 v[44:47], v3, s[8:11], s39 offen offset:1024 sc1
    s_branch L_std_124
L_gidle_116:
    v_lshlrev_b32 v8, 7, v1
    s_and_b32 s40, s19, 1
    s_lshl_b32 s40, s40, 2
    s_add_u32 s40, s40, s16
    s_mul_i32 s41, s40, 176128
    s_add_u32 s41, s41, 52494336
    s_barrier
    s_cmp_eq_u32 s24, 0
    s_cbranch_scc1 L_gq0_126
    buffer_load_dword v9, v8, s[8:11], s41 offen
    s_add_u32 s41, s41, 8192
    buffer_load_dword v9, v8, s[8:11], s41 offen
    s_add_u32 s41, s41, 8192
    buffer_load_dword v9, v8, s[8:11], s41 offen
    s_add_u32 s41, s41, 8192
    buffer_load_dword v9, v8, s[8:11], s41 offen
    s_add_u32 s41, s41, 8192
    buffer_load_dword v9, v8, s[8:11], s41 offen
    s_add_u32 s41, s41, 8192
    buffer_load_dword v9, v8, s[8:11], s41 offen
    s_add_u32 s41, s41, 8192
    s_branch L_gq_125
L_gq0_126:
    s_mul_i32 s41, s40, 196608
    s_add_u32 s41, s41, 58720256
    s_add_u32 s42, s41, 98304
    buffer_load_dword v9, v8, s[8:11], s41 offen
    s_add_u32 s41, s41, 8192
    buffer_load_dword v9, v8, s[8:11], s42 offen
    s_add_u32 s42, s42, 8192
    buffer_load_dword v9, v8, s[8:11], s41 offen
    s_add_u32 s41, s41, 8192
    buffer_load_dword v9, v8, s[8:11], s42 offen
    s_add_u32 s42, s42, 8192
    buffer_load_dword v9, v8, s[8:11], s41 offen
    s_add_u32 s41, s41, 8192
    buffer_load_dword v9, v8, s[8:11], s42 offen
    s_add_u32 s42, s42, 8192
L_gq_125:
    s_barrier
    s_barrier
    s_barrier
    s_barrier
    s_barrier
    s_barrier
    s_branch L_gjoin_117
L_sts_128:
    buffer_store_dwordx4 v[72:75], v3, s[8:11], s39 offen sc1
    buffer_store_dwordx4 v[76:79], v3, s[8:11], s39 offen offset:1024 sc1
    s_branch L_std_129
L_sts_131:
    buffer_store_dword v2, v253, s[8:11], s21 offen sc1
    s_branch L_std_132
L_sts_149:
    buffer_store_dwordx4 v[236:239], v3, s[8:11], s37 offen sc1
    buffer_store_dwordx4 v[240:243], v3, s[8:11], s37 offen offset:1024 sc1
    s_branch L_std_150
L_sts_151:
    buffer_store_dword v86, v3, s[8:11], s44 offen sc1
    s_branch L_std_152
L_sts_153:
    buffer_store_dword v2, v253, s[8:11], s21 offen sc1
    s_branch L_std_154
L_sts_160:
    buffer_store_dwordx4 v[8:11], v3, s[8:11], s38 offen sc1
    buffer_store_dwordx4 v[12:15], v3, s[8:11], s38 offen offset:1024 sc1
    s_branch L_std_161
L_sts_162:
    buffer_store_dword v2, v253, s[8:11], s21 offen sc1
    s_branch L_std_163
L_code_end:
.section .rodata,"a"
.p2align 6
.amdhsa_kernel interleave_layers__mha_block__glu_gated_bilinear__prompt_kernel
  .amdhsa_next_free_vgpr 256
  .amdhsa_next_free_sgpr 100
  .amdhsa_accum_offset 256
  .amdhsa_group_segment_fixed_size 0
  .amdhsa_kernarg_size 80
  .amdhsa_user_sgpr_count 2
  .amdhsa_user_sgpr_kernarg_segment_ptr 1
  .amdhsa_system_sgpr_workgroup_id_x 1
.end_amdhsa_kernel
```
